```python
import torch

def _softmax(x, axis=-1):
    return torch.softmax(x, dim=axis)
def _gelu(x):
    return torch.nn.functional.gelu(x, approximate="tanh")
def _silu(x):
    return torch.nn.functional.silu(x)
def _sigmoid(x):
    return torch.sigmoid(x)
def _layernorm(x, axis=-1, eps=1e-5):
    m = x.mean(dim=axis, keepdim=True)
    v = x.var(dim=axis, keepdim=True, unbiased=False)
    return (x - m) / torch.sqrt(v + eps)
def _scatter_add(tgt, idx, src, axis=0):
    return tgt.clone().index_add_(axis, idx, src)
def _segment_sum(src, seg, n):
    out = torch.zeros((n,) + src.shape[1:], dtype=src.dtype)
    return out.index_add_(0, seg, src)
def _pad(x, pw):
    flat = tuple(v for pair in reversed(pw) for v in pair)
    return torch.nn.functional.pad(x, flat)

kernel_name = 'standalone__geglu_ffn__prompt'

def setup_inputs():

    _w = (lambda a: (lambda t: t.to(torch.bfloat16) if t.is_floating_point() else t)(torch.as_tensor(a)))
    B, S, D, F = 1, 2048, 448, 1792
    return {
        "x": _w((lambda *s: torch.randn(*s, dtype=torch.bfloat16) * 0.05)(B, S, D)),
        "w_gate": _w((lambda *s: torch.randn(*s, dtype=torch.bfloat16) * 0.05)(D, F)),
        "w_up": _w((lambda *s: torch.randn(*s, dtype=torch.bfloat16) * 0.05)(D, F)),
        "w_down": _w((lambda *s: torch.randn(*s, dtype=torch.bfloat16) * 0.05)(F, D)),
    }

def reference(x, w_gate, w_up, w_down):
    return (_gelu(x @ w_gate) * (x @ w_up)) @ w_down
```

```asm
; @launch grid=(256,1,1) block=(448,1,1) lds=163840
.amdgcn_target "amdgcn-amd-amdhsa--gfx950"
.text
.globl standalone__geglu_ffn__prompt_kernel
.p2align 8
.type standalone__geglu_ffn__prompt_kernel,@function
standalone__geglu_ffn__prompt_kernel:
KSTART:
    s_cmp_ge_u32 s2, 256
    s_cbranch_scc1 L_end
    s_load_dwordx4 s[4:7], s[0:1], 0
    s_load_dwordx4 s[8:11], s[0:1], 16
    s_load_dwordx4 s[12:15], s[0:1], 32
    s_load_dwordx2 s[16:17], s[0:1], 48

    v_and_b32 v1, 63, v0
    v_lshrrev_b32 v2, 6, v0
    s_and_b32 s19, s2, 7
    v_readfirstlane_b32 s18, v2
    s_lshr_b32 s20, s2, 3
    s_mul_i32 s21, s20, 37
    s_lshr_b32 s21, s21, 8
    s_mul_i32 s22, s21, 7
    s_sub_u32 s22, s20, s22
    s_and_b32 s52, s19, 3
    s_lshl_b32 s52, s52, 2
    s_add_u32 s52, s52, s21
    s_lshr_b32 s53, s19, 2
    s_mul_i32 s53, s53, 7
    s_add_u32 s53, s53, s22
    s_lshl_b32 s54, s19, 2
    s_add_u32 s54, s54, s21
    s_mov_b32 s55, s22
    s_mul_i32 s23, s21, 2
    s_add_u32 s23, s23, s22
    s_cmp_ge_u32 s23, 7
    s_cselect_b32 s56, 7, 0
    s_sub_u32 s23, s23, s56

    s_add_u32 s60, s23, 0
    s_cmp_ge_u32 s60, 7
    s_cselect_b32 s56, 7, 0
    s_sub_u32 s60, s60, s56

    s_add_u32 s61, s23, 1
    s_cmp_ge_u32 s61, 7
    s_cselect_b32 s56, 7, 0
    s_sub_u32 s61, s61, s56

    s_add_u32 s62, s23, 2
    s_cmp_ge_u32 s62, 7
    s_cselect_b32 s56, 7, 0
    s_sub_u32 s62, s62, s56

    s_add_u32 s63, s23, 3
    s_cmp_ge_u32 s63, 7
    s_cselect_b32 s56, 7, 0
    s_sub_u32 s63, s63, s56

    s_add_u32 s64, s23, 4
    s_cmp_ge_u32 s64, 7
    s_cselect_b32 s56, 7, 0
    s_sub_u32 s64, s64, s56

    s_add_u32 s65, s23, 5
    s_cmp_ge_u32 s65, 7
    s_cselect_b32 s56, 7, 0
    s_sub_u32 s65, s65, s56

    s_add_u32 s66, s23, 6
    s_cmp_ge_u32 s66, 7
    s_cselect_b32 s56, 7, 0
    s_sub_u32 s66, s66, s56

    s_cmp_ge_u32 s2, 224
    s_cbranch_scc1 L_helper
    s_cmp_eq_u32 s18, 4
    s_cbranch_scc1 L_loader
    s_cmp_eq_u32 s18, 6
    s_cbranch_scc1 L_loader
    s_cmp_eq_u32 s18, 5
    s_cbranch_scc1 L_poller

    v_lshrrev_b32 v24, 3, v1
    v_mul_u32_u24 v25, 896, v24
    v_and_b32 v26, 7, v1
    v_lshrrev_b32 v27, 4, v1
    v_xor_b32 v28, v26, v27
    v_lshl_add_u32 v2, v28, 4, v25
    v_xor_b32 v28, 4, v28
    v_lshl_add_u32 v3, v28, 4, v25
    s_mul_i32 s56, s52, 114688
    s_mul_i32 s57, s18, 28672
    s_add_u32 s56, s56, s57
    v_add_u32 v2, s56, v2
    s_add_u32 s56, s56, 6144
    v_add_u32 v3, s56, v3
    v_add_u32 v4, 12288, v2
    v_add_u32 v5, 12288, v3
    v_mul_u32_u24 v25, 3584, v24
    v_bfe_u32 v27, v1, 4, 1
    v_lshlrev_b32 v28, 1, v27
    v_xor_b32 v28, v26, v28
    s_lshr_b32 s56, s18, 1
    s_lshl_b32 s57, s56, 2
    v_xor_b32 v28, s57, v28
    v_lshl_add_u32 v48, v28, 4, v25
    s_lshl_b32 s57, s53, 8
    s_and_b32 s59, s18, 1
    s_mul_i32 s59, s59, 114688
    s_add_u32 s57, s57, s59
    v_add_u32 v48, s57, v48
    v_add_u32 v49, 27648, v48
    v_add_u32 v50, 55296, v48
    v_add_u32 v51, 82944, v48
    s_lshl_b32 s57, s56, 13
    s_and_b32 s59, s18, 1
    s_lshl_b32 s59, s59, 12
    s_add_u32 s32, s57, s59
    s_add_u32 s32, s32, 114688
    s_lshl_b32 s58, s18, 12
    s_waitcnt lgkmcnt(0)
    s_cmp_eq_u32 s56, 0
    s_cselect_b32 s28, s6, s8
    s_cselect_b32 s29, s7, s9
    s_mov_b32 s30, 1605632
    s_mov_b32 s31, 0x20000

    s_mov_b32 s24, s4
    s_mov_b32 s25, s5
    s_mov_b32 s26, 1835008
    s_mov_b32 s27, 0x20000

    s_add_u32 s57, s58, 0
    s_mov_b32 m0, s57
    s_lshl_b32 s59, s60, 7
    buffer_load_dwordx4 v2, s[24:27], s59 offen lds
    buffer_load_dwordx4 v3, s[24:27], s59 offen offset:1024 lds
    buffer_load_dwordx4 v4, s[24:27], s59 offen offset:2048 lds
    buffer_load_dwordx4 v5, s[24:27], s59 offen offset:3072 lds

    s_add_u32 s57, s32, 0
    s_mov_b32 m0, s57
    s_mul_i32 s59, s60, 229376
    buffer_load_dwordx4 v48, s[28:31], s59 offen lds
    buffer_load_dwordx4 v49, s[28:31], s59 offen offset:1024 lds
    buffer_load_dwordx4 v50, s[28:31], s59 offen offset:2048 lds
    buffer_load_dwordx4 v51, s[28:31], s59 offen offset:3072 lds

    s_add_u32 s57, s58, 16384
    s_mov_b32 m0, s57
    s_lshl_b32 s59, s61, 7
    buffer_load_dwordx4 v2, s[24:27], s59 offen lds
    buffer_load_dwordx4 v3, s[24:27], s59 offen offset:1024 lds
    buffer_load_dwordx4 v4, s[24:27], s59 offen offset:2048 lds
    buffer_load_dwordx4 v5, s[24:27], s59 offen offset:3072 lds

    s_add_u32 s57, s32, 16384
    s_mov_b32 m0, s57
    s_mul_i32 s59, s61, 229376
    buffer_load_dwordx4 v48, s[28:31], s59 offen lds
    buffer_load_dwordx4 v49, s[28:31], s59 offen offset:1024 lds
    buffer_load_dwordx4 v50, s[28:31], s59 offen offset:2048 lds
    buffer_load_dwordx4 v51, s[28:31], s59 offen offset:3072 lds

s_barrier
    s_mov_b32 s40, s16
    s_mov_b32 s41, s17
    s_mov_b32 s42, 9437184
    s_mov_b32 s43, 0x20000

    s_mov_b32 s44, s12
    s_mov_b32 s45, s13
    s_mov_b32 s46, 1835008
    s_mov_b32 s47, 0x20000

    v_lshrrev_b32 v24, 5, v1
    v_bfe_u32 v25, v1, 4, 1
    v_bfe_u32 v26, v1, 2, 2
    v_and_b32 v27, 3, v1
    v_lshl_add_u32 v28, v24, 3, v26
    v_lshlrev_b32 v28, 7, v28
    v_lshl_add_u32 v28, v25, 13, v28
    v_lshl_add_u32 v28, v27, 3, v28
    v_add_u32 v28, 114688, v28
    v_bfe_u32 v29, v1, 3, 1
    v_lshl_add_u32 v29, v25, 1, v29
    s_lshr_b32 s56, s18, 1
    s_lshl_b32 s56, s56, 1
    v_xor_b32 v30, s56, v29
    v_lshl_add_u32 v6, v30, 5, v28
    v_xor_b32 v7, 32, v6
    v_and_b32 v26, 31, v1
    v_bfe_u32 v27, v1, 1, 3
    v_xor_b32 v27, v27, v24
    v_lshlrev_b32 v27, 4, v27
    v_lshl_add_u32 v27, v26, 7, v27
    s_and_b32 s56, s18, 1
    s_lshl_b32 s56, s56, 13
    v_add_u32 v8, s56, v27
    v_xor_b32 v9, 32, v8
    v_xor_b32 v10, 64, v8
    v_xor_b32 v11, 96, v8
    v_add_u32 v12, 0x10000, v8
    v_add_u32 v13, 0x10000, v9
    v_add_u32 v14, 0x10000, v10
    v_add_u32 v15, 0x10000, v11
    v_bfe_u32 v26, v1, 2, 2
    v_lshl_add_u32 v26, v24, 2, v26
    s_lshr_b32 s56, s18, 1
    s_lshl_b32 s57, s56, 6
    v_add_u32 v26, s57, v26
    v_lshlrev_b32 v26, 7, v26
    v_bfe_u32 v27, v1, 3, 1
    v_lshlrev_b32 v27, 1, v27
    v_xor_b32 v27, v27, v25
    s_lshl_b32 s57, s56, 1
    v_xor_b32 v27, s57, v27
    v_lshl_add_u32 v26, v27, 5, v26
    v_and_b32 v27, 3, v1
    v_lshl_add_u32 v16, v27, 3, v26
    v_xor_b32 v17, 64, v16
    v_lshlrev_b32 v22, 4, v1
    s_mov_b32 s67, 3222493025
    s_mov_b32 s68, 3184710632
    s_mov_b32 s69, 3184710632
    v_mov_b32 v23, s67
    v_mov_b32 v52, s70
    v_mov_b32 v53, s70
    s_and_b32 s56, s18, 1
    s_lshl_b32 s56, s56, 1
    s_lshl_b32 s57, s52, 2
    s_add_u32 s56, s56, s57
    s_mul_i32 s56, s56, 112
    s_lshl_b32 s57, s53, 3
    s_add_u32 s56, s56, s57
    s_lshr_b32 s57, s18, 1
    s_lshl_b32 s57, s57, 1
    s_add_u32 s56, s56, s57
    s_lshl_b32 s36, s56, 10
    s_add_u32 s37, s36, 114688
    s_add_u32 s38, s36, 4096
    s_add_u32 s39, s37, 4096

    s_lshl_b32 s56, s54, 1
    s_and_b32 s57, s18, 1
    s_add_u32 s56, s56, s57
    s_mul_i32 s56, s56, 112
    s_lshr_b32 s57, s18, 1
    s_lshl_b32 s57, s57, 3
    s_add_u32 s56, s56, s57
    s_lshl_b32 s56, s56, 10
    v_mov_b32 v4, s67
    v_mov_b32 v5, s67

    s_mov_b32 s24, s14
    s_mov_b32 s25, s15
    s_mov_b32 s26, 256
    s_mov_b32 s27, 0x20000
    v_min_u32 v2, 13, v1
    v_and_b32 v3, 1, v2
    v_lshrrev_b32 v2, 1, v2
    v_add_u32 v2, s23, v2
    v_subrev_u32 v24, 7, v2
    v_cmp_le_u32 vcc, 7, v2
    s_nop 1
    v_cndmask_b32 v2, v2, v24, vcc
    v_lshlrev_b32 v2, 1, v2
    s_lshr_b32 s57, s18, 1
    v_add_u32 v2, s57, v2
    v_lshlrev_b32 v2, 7, v2
    v_lshl_add_u32 v2, v3, 4, v2
    s_and_b32 s57, s54, 1
    s_lshl_b32 s57, s57, 3
    v_add_u32 v2, s57, v2
    s_lshr_b32 s32, s54, 1
    s_lshl_b32 s32, s32, 11
    s_add_u32 s32, s32, 8421376
    s_lshl_b32 s21, s52, 4
    s_add_u32 s21, s21, s53
    s_lshl_b32 s21, s21, 7
    s_lshl_b32 s57, s18, 3
    s_add_u32 s21, s21, s57
    s_add_u32 s21, s21, 8421376
    v_mov_b32 v3, 0

    s_cmp_eq_u32 s60, 5
    s_cselect_b32 s57, 9, s60
    s_cmp_eq_u32 s60, 6
    s_cselect_b32 s57, 5, s57
    s_lshl_b32 s48, s57, 14
    s_lshl_b32 s60, s60, 14
    s_add_u32 s60, s60, s56

    s_cmp_eq_u32 s61, 5
    s_cselect_b32 s57, 9, s61
    s_cmp_eq_u32 s61, 6
    s_cselect_b32 s57, 5, s57
    s_lshl_b32 s49, s57, 14
    s_lshl_b32 s61, s61, 14
    s_add_u32 s61, s61, s56

    s_cmp_eq_u32 s62, 5
    s_cselect_b32 s57, 9, s62
    s_cmp_eq_u32 s62, 6
    s_cselect_b32 s57, 5, s57
    s_lshl_b32 s50, s57, 14
    s_lshl_b32 s62, s62, 14
    s_add_u32 s62, s62, s56

    s_cmp_eq_u32 s63, 5
    s_cselect_b32 s57, 9, s63
    s_cmp_eq_u32 s63, 6
    s_cselect_b32 s57, 5, s57
    s_lshl_b32 s51, s57, 14
    s_lshl_b32 s63, s63, 14
    s_add_u32 s63, s63, s56

    s_cmp_eq_u32 s64, 5
    s_cselect_b32 s57, 9, s64
    s_cmp_eq_u32 s64, 6
    s_cselect_b32 s57, 5, s57
    s_lshl_b32 s33, s57, 14
    s_lshl_b32 s64, s64, 14
    s_add_u32 s64, s64, s56

    s_cmp_eq_u32 s65, 5
    s_cselect_b32 s57, 9, s65
    s_cmp_eq_u32 s65, 6
    s_cselect_b32 s57, 5, s57
    s_lshl_b32 s34, s57, 14
    s_lshl_b32 s65, s65, 14
    s_add_u32 s65, s65, s56

    s_cmp_eq_u32 s66, 5
    s_cselect_b32 s57, 9, s66
    s_cmp_eq_u32 s66, 6
    s_cselect_b32 s57, 5, s57
    s_lshl_b32 s35, s57, 14
    s_lshl_b32 s66, s66, 14
    s_add_u32 s66, s66, s56

s_waitcnt vmcnt(8)
s_barrier
ds_read_b128 v[48:51], v8 offset:0
ds_read_b64_tr_b16 v[56:57], v6 offset:0
ds_read_b64_tr_b16 v[58:59], v6 offset:512
ds_read_b128 v[52:55], v8 offset:4096
ds_read_b64_tr_b16 v[60:61], v7 offset:0
ds_read_b64_tr_b16 v[62:63], v7 offset:512
ds_read_b128 v[64:67], v9 offset:0
ds_read_b64_tr_b16 v[72:73], v6 offset:2048
ds_read_b64_tr_b16 v[74:75], v6 offset:2560
ds_read_b128 v[68:71], v9 offset:4096
ds_read_b64_tr_b16 v[76:77], v7 offset:2048
ds_read_b64_tr_b16 v[78:79], v7 offset:2560
s_waitcnt lgkmcnt(6)
v_mfma_f32_32x32x16_bf16 v[112:127], v[56:59], v[48:51], 0
ds_read_b128 v[80:83], v10 offset:0
ds_read_b64_tr_b16 v[88:89], v6 offset:4096
v_mfma_f32_32x32x16_bf16 v[128:143], v[56:59], v[52:55], 0
ds_read_b64_tr_b16 v[90:91], v6 offset:4608
ds_read_b128 v[84:87], v10 offset:4096
v_mfma_f32_32x32x16_bf16 v[144:159], v[60:63], v[48:51], 0
ds_read_b64_tr_b16 v[92:93], v7 offset:4096
v_mfma_f32_32x32x16_bf16 v[160:175], v[60:63], v[52:55], 0
ds_read_b64_tr_b16 v[94:95], v7 offset:4608
s_waitcnt lgkmcnt(6)
v_mfma_f32_32x32x16_bf16 v[112:127], v[72:75], v[64:67], v[112:127]
ds_read_b128 v[96:99], v11 offset:0
ds_read_b64_tr_b16 v[104:105], v6 offset:6144
ds_read_b64_tr_b16 v[106:107], v6 offset:6656
v_mfma_f32_32x32x16_bf16 v[128:143], v[72:75], v[68:71], v[128:143]
ds_read_b128 v[100:103], v11 offset:4096
ds_read_b64_tr_b16 v[108:109], v7 offset:6144
ds_read_b64_tr_b16 v[110:111], v7 offset:6656
v_mfma_f32_32x32x16_bf16 v[144:159], v[76:79], v[64:67], v[144:159]
v_mfma_f32_32x32x16_bf16 v[160:175], v[76:79], v[68:71], v[160:175]
s_waitcnt vmcnt(0) lgkmcnt(0)
s_barrier
v_mfma_f32_32x32x16_bf16 v[112:127], v[88:91], v[80:83], v[112:127]
ds_read_b128 v[48:51], v8 offset:16384
ds_read_b64_tr_b16 v[56:57], v6 offset:16384
v_mfma_f32_32x32x16_bf16 v[128:143], v[88:91], v[84:87], v[128:143]
ds_read_b64_tr_b16 v[58:59], v6 offset:16896
ds_read_b128 v[52:55], v8 offset:20480
v_mfma_f32_32x32x16_bf16 v[144:159], v[92:95], v[80:83], v[144:159]
ds_read_b64_tr_b16 v[60:61], v7 offset:16384
v_mfma_f32_32x32x16_bf16 v[160:175], v[92:95], v[84:87], v[160:175]
ds_read_b64_tr_b16 v[62:63], v7 offset:16896
s_waitcnt lgkmcnt(6)
v_mfma_f32_32x32x16_bf16 v[112:127], v[104:107], v[96:99], v[112:127]
ds_read_b128 v[64:67], v9 offset:16384
ds_read_b64_tr_b16 v[72:73], v6 offset:18432
v_mfma_f32_32x32x16_bf16 v[128:143], v[104:107], v[100:103], v[128:143]
ds_read_b64_tr_b16 v[74:75], v6 offset:18944
ds_read_b128 v[68:71], v9 offset:20480
v_mfma_f32_32x32x16_bf16 v[144:159], v[108:111], v[96:99], v[144:159]
ds_read_b64_tr_b16 v[76:77], v7 offset:18432
v_mfma_f32_32x32x16_bf16 v[160:175], v[108:111], v[100:103], v[160:175]
ds_read_b64_tr_b16 v[78:79], v7 offset:18944
s_waitcnt lgkmcnt(6)
v_mfma_f32_32x32x16_bf16 v[112:127], v[56:59], v[48:51], v[112:127]
ds_read_b128 v[80:83], v10 offset:16384
ds_read_b64_tr_b16 v[88:89], v6 offset:20480
v_mfma_f32_32x32x16_bf16 v[128:143], v[56:59], v[52:55], v[128:143]
ds_read_b64_tr_b16 v[90:91], v6 offset:20992
ds_read_b128 v[84:87], v10 offset:20480
v_mfma_f32_32x32x16_bf16 v[144:159], v[60:63], v[48:51], v[144:159]
ds_read_b64_tr_b16 v[92:93], v7 offset:20480
v_mfma_f32_32x32x16_bf16 v[160:175], v[60:63], v[52:55], v[160:175]
ds_read_b64_tr_b16 v[94:95], v7 offset:20992
s_waitcnt lgkmcnt(6)
v_mfma_f32_32x32x16_bf16 v[112:127], v[72:75], v[64:67], v[112:127]
ds_read_b128 v[96:99], v11 offset:16384
ds_read_b64_tr_b16 v[104:105], v6 offset:22528
ds_read_b64_tr_b16 v[106:107], v6 offset:23040
v_mfma_f32_32x32x16_bf16 v[128:143], v[72:75], v[68:71], v[128:143]
ds_read_b128 v[100:103], v11 offset:20480
ds_read_b64_tr_b16 v[108:109], v7 offset:22528
ds_read_b64_tr_b16 v[110:111], v7 offset:23040
v_mfma_f32_32x32x16_bf16 v[144:159], v[76:79], v[64:67], v[144:159]
v_mfma_f32_32x32x16_bf16 v[160:175], v[76:79], v[68:71], v[160:175]
s_waitcnt lgkmcnt(0)
s_barrier
v_mfma_f32_32x32x16_bf16 v[112:127], v[88:91], v[80:83], v[112:127]
ds_read_b128 v[48:51], v8 offset:32768
ds_read_b64_tr_b16 v[56:57], v6 offset:32768
v_mfma_f32_32x32x16_bf16 v[128:143], v[88:91], v[84:87], v[128:143]
ds_read_b64_tr_b16 v[58:59], v6 offset:33280
ds_read_b128 v[52:55], v8 offset:36864
v_mfma_f32_32x32x16_bf16 v[144:159], v[92:95], v[80:83], v[144:159]
ds_read_b64_tr_b16 v[60:61], v7 offset:32768
v_mfma_f32_32x32x16_bf16 v[160:175], v[92:95], v[84:87], v[160:175]
ds_read_b64_tr_b16 v[62:63], v7 offset:33280
s_waitcnt lgkmcnt(6)
v_mfma_f32_32x32x16_bf16 v[112:127], v[104:107], v[96:99], v[112:127]
ds_read_b128 v[64:67], v9 offset:32768
ds_read_b64_tr_b16 v[72:73], v6 offset:34816
v_mfma_f32_32x32x16_bf16 v[128:143], v[104:107], v[100:103], v[128:143]
ds_read_b64_tr_b16 v[74:75], v6 offset:35328
ds_read_b128 v[68:71], v9 offset:36864
v_mfma_f32_32x32x16_bf16 v[144:159], v[108:111], v[96:99], v[144:159]
ds_read_b64_tr_b16 v[76:77], v7 offset:34816
v_mfma_f32_32x32x16_bf16 v[160:175], v[108:111], v[100:103], v[160:175]
ds_read_b64_tr_b16 v[78:79], v7 offset:35328
s_waitcnt lgkmcnt(6)
v_mfma_f32_32x32x16_bf16 v[112:127], v[56:59], v[48:51], v[112:127]
ds_read_b128 v[80:83], v10 offset:32768
ds_read_b64_tr_b16 v[88:89], v6 offset:36864
v_mfma_f32_32x32x16_bf16 v[128:143], v[56:59], v[52:55], v[128:143]
ds_read_b64_tr_b16 v[90:91], v6 offset:37376
ds_read_b128 v[84:87], v10 offset:36864
v_mfma_f32_32x32x16_bf16 v[144:159], v[60:63], v[48:51], v[144:159]
ds_read_b64_tr_b16 v[92:93], v7 offset:36864
v_mfma_f32_32x32x16_bf16 v[160:175], v[60:63], v[52:55], v[160:175]
ds_read_b64_tr_b16 v[94:95], v7 offset:37376
s_waitcnt lgkmcnt(6)
v_mfma_f32_32x32x16_bf16 v[112:127], v[72:75], v[64:67], v[112:127]
ds_read_b128 v[96:99], v11 offset:32768
ds_read_b64_tr_b16 v[104:105], v6 offset:38912
ds_read_b64_tr_b16 v[106:107], v6 offset:39424
v_mfma_f32_32x32x16_bf16 v[128:143], v[72:75], v[68:71], v[128:143]
ds_read_b128 v[100:103], v11 offset:36864
ds_read_b64_tr_b16 v[108:109], v7 offset:38912
ds_read_b64_tr_b16 v[110:111], v7 offset:39424
v_mfma_f32_32x32x16_bf16 v[144:159], v[76:79], v[64:67], v[144:159]
v_mfma_f32_32x32x16_bf16 v[160:175], v[76:79], v[68:71], v[160:175]
s_waitcnt lgkmcnt(0)
s_barrier
v_mfma_f32_32x32x16_bf16 v[112:127], v[88:91], v[80:83], v[112:127]
ds_read_b128 v[48:51], v8 offset:49152
ds_read_b64_tr_b16 v[56:57], v6 offset:0
v_mfma_f32_32x32x16_bf16 v[128:143], v[88:91], v[84:87], v[128:143]
ds_read_b64_tr_b16 v[58:59], v6 offset:512
ds_read_b128 v[52:55], v8 offset:53248
v_mfma_f32_32x32x16_bf16 v[144:159], v[92:95], v[80:83], v[144:159]
ds_read_b64_tr_b16 v[60:61], v7 offset:0
v_mfma_f32_32x32x16_bf16 v[160:175], v[92:95], v[84:87], v[160:175]
ds_read_b64_tr_b16 v[62:63], v7 offset:512
s_waitcnt lgkmcnt(6)
v_mfma_f32_32x32x16_bf16 v[112:127], v[104:107], v[96:99], v[112:127]
ds_read_b128 v[64:67], v9 offset:49152
ds_read_b64_tr_b16 v[72:73], v6 offset:2048
v_mfma_f32_32x32x16_bf16 v[128:143], v[104:107], v[100:103], v[128:143]
ds_read_b64_tr_b16 v[74:75], v6 offset:2560
ds_read_b128 v[68:71], v9 offset:53248
v_mfma_f32_32x32x16_bf16 v[144:159], v[108:111], v[96:99], v[144:159]
ds_read_b64_tr_b16 v[76:77], v7 offset:2048
v_mfma_f32_32x32x16_bf16 v[160:175], v[108:111], v[100:103], v[160:175]
ds_read_b64_tr_b16 v[78:79], v7 offset:2560
s_waitcnt lgkmcnt(6)
v_mfma_f32_32x32x16_bf16 v[112:127], v[56:59], v[48:51], v[112:127]
ds_read_b128 v[80:83], v10 offset:49152
ds_read_b64_tr_b16 v[88:89], v6 offset:4096
v_mfma_f32_32x32x16_bf16 v[128:143], v[56:59], v[52:55], v[128:143]
ds_read_b64_tr_b16 v[90:91], v6 offset:4608
ds_read_b128 v[84:87], v10 offset:53248
v_mfma_f32_32x32x16_bf16 v[144:159], v[60:63], v[48:51], v[144:159]
ds_read_b64_tr_b16 v[92:93], v7 offset:4096
v_mfma_f32_32x32x16_bf16 v[160:175], v[60:63], v[52:55], v[160:175]
ds_read_b64_tr_b16 v[94:95], v7 offset:4608
s_waitcnt lgkmcnt(6)
v_mfma_f32_32x32x16_bf16 v[112:127], v[72:75], v[64:67], v[112:127]
ds_read_b128 v[96:99], v11 offset:49152
ds_read_b64_tr_b16 v[104:105], v6 offset:6144
ds_read_b64_tr_b16 v[106:107], v6 offset:6656
v_mfma_f32_32x32x16_bf16 v[128:143], v[72:75], v[68:71], v[128:143]
ds_read_b128 v[100:103], v11 offset:53248
ds_read_b64_tr_b16 v[108:109], v7 offset:6144
ds_read_b64_tr_b16 v[110:111], v7 offset:6656
v_mfma_f32_32x32x16_bf16 v[144:159], v[76:79], v[64:67], v[144:159]
v_mfma_f32_32x32x16_bf16 v[160:175], v[76:79], v[68:71], v[160:175]
s_waitcnt lgkmcnt(0)
s_barrier
v_mfma_f32_32x32x16_bf16 v[112:127], v[88:91], v[80:83], v[112:127]
ds_read_b128 v[48:51], v12 offset:0
ds_read_b64_tr_b16 v[56:57], v6 offset:16384
v_mfma_f32_32x32x16_bf16 v[128:143], v[88:91], v[84:87], v[128:143]
ds_read_b64_tr_b16 v[58:59], v6 offset:16896
ds_read_b128 v[52:55], v12 offset:4096
v_mfma_f32_32x32x16_bf16 v[144:159], v[92:95], v[80:83], v[144:159]
ds_read_b64_tr_b16 v[60:61], v7 offset:16384
v_mfma_f32_32x32x16_bf16 v[160:175], v[92:95], v[84:87], v[160:175]
ds_read_b64_tr_b16 v[62:63], v7 offset:16896
s_waitcnt lgkmcnt(6)
v_mfma_f32_32x32x16_bf16 v[112:127], v[104:107], v[96:99], v[112:127]
ds_read_b128 v[64:67], v13 offset:0
ds_read_b64_tr_b16 v[72:73], v6 offset:18432
v_mfma_f32_32x32x16_bf16 v[128:143], v[104:107], v[100:103], v[128:143]
ds_read_b64_tr_b16 v[74:75], v6 offset:18944
ds_read_b128 v[68:71], v13 offset:4096
v_mfma_f32_32x32x16_bf16 v[144:159], v[108:111], v[96:99], v[144:159]
ds_read_b64_tr_b16 v[76:77], v7 offset:18432
v_mfma_f32_32x32x16_bf16 v[160:175], v[108:111], v[100:103], v[160:175]
ds_read_b64_tr_b16 v[78:79], v7 offset:18944
s_waitcnt lgkmcnt(6)
v_mfma_f32_32x32x16_bf16 v[112:127], v[56:59], v[48:51], v[112:127]
ds_read_b128 v[80:83], v14 offset:0
ds_read_b64_tr_b16 v[88:89], v6 offset:20480
v_mfma_f32_32x32x16_bf16 v[128:143], v[56:59], v[52:55], v[128:143]
ds_read_b64_tr_b16 v[90:91], v6 offset:20992
ds_read_b128 v[84:87], v14 offset:4096
v_mfma_f32_32x32x16_bf16 v[144:159], v[60:63], v[48:51], v[144:159]
ds_read_b64_tr_b16 v[92:93], v7 offset:20480
v_mfma_f32_32x32x16_bf16 v[160:175], v[60:63], v[52:55], v[160:175]
ds_read_b64_tr_b16 v[94:95], v7 offset:20992
s_waitcnt lgkmcnt(6)
v_mfma_f32_32x32x16_bf16 v[112:127], v[72:75], v[64:67], v[112:127]
ds_read_b128 v[96:99], v15 offset:0
ds_read_b64_tr_b16 v[104:105], v6 offset:22528
ds_read_b64_tr_b16 v[106:107], v6 offset:23040
v_mfma_f32_32x32x16_bf16 v[128:143], v[72:75], v[68:71], v[128:143]
ds_read_b128 v[100:103], v15 offset:4096
ds_read_b64_tr_b16 v[108:109], v7 offset:22528
ds_read_b64_tr_b16 v[110:111], v7 offset:23040
v_mfma_f32_32x32x16_bf16 v[144:159], v[76:79], v[64:67], v[144:159]
v_mfma_f32_32x32x16_bf16 v[160:175], v[76:79], v[68:71], v[160:175]
s_waitcnt lgkmcnt(0)
s_barrier
v_mfma_f32_32x32x16_bf16 v[112:127], v[88:91], v[80:83], v[112:127]
ds_read_b128 v[48:51], v12 offset:16384
ds_read_b64_tr_b16 v[56:57], v6 offset:32768
v_mfma_f32_32x32x16_bf16 v[128:143], v[88:91], v[84:87], v[128:143]
ds_read_b64_tr_b16 v[58:59], v6 offset:33280
ds_read_b128 v[52:55], v12 offset:20480
v_mfma_f32_32x32x16_bf16 v[144:159], v[92:95], v[80:83], v[144:159]
ds_read_b64_tr_b16 v[60:61], v7 offset:32768
v_mfma_f32_32x32x16_bf16 v[160:175], v[92:95], v[84:87], v[160:175]
ds_read_b64_tr_b16 v[62:63], v7 offset:33280
s_waitcnt lgkmcnt(6)
v_mfma_f32_32x32x16_bf16 v[112:127], v[104:107], v[96:99], v[112:127]
ds_read_b128 v[64:67], v13 offset:16384
ds_read_b64_tr_b16 v[72:73], v6 offset:34816
v_mfma_f32_32x32x16_bf16 v[128:143], v[104:107], v[100:103], v[128:143]
ds_read_b64_tr_b16 v[74:75], v6 offset:35328
ds_read_b128 v[68:71], v13 offset:20480
v_mfma_f32_32x32x16_bf16 v[144:159], v[108:111], v[96:99], v[144:159]
ds_read_b64_tr_b16 v[76:77], v7 offset:34816
v_mfma_f32_32x32x16_bf16 v[160:175], v[108:111], v[100:103], v[160:175]
ds_read_b64_tr_b16 v[78:79], v7 offset:35328
s_waitcnt lgkmcnt(6)
v_mfma_f32_32x32x16_bf16 v[112:127], v[56:59], v[48:51], v[112:127]
ds_read_b128 v[80:83], v14 offset:16384
ds_read_b64_tr_b16 v[88:89], v6 offset:36864
v_mfma_f32_32x32x16_bf16 v[128:143], v[56:59], v[52:55], v[128:143]
ds_read_b64_tr_b16 v[90:91], v6 offset:37376
ds_read_b128 v[84:87], v14 offset:20480
v_mfma_f32_32x32x16_bf16 v[144:159], v[60:63], v[48:51], v[144:159]
ds_read_b64_tr_b16 v[92:93], v7 offset:36864
v_mfma_f32_32x32x16_bf16 v[160:175], v[60:63], v[52:55], v[160:175]
ds_read_b64_tr_b16 v[94:95], v7 offset:37376
s_waitcnt lgkmcnt(6)
v_mfma_f32_32x32x16_bf16 v[112:127], v[72:75], v[64:67], v[112:127]
ds_read_b128 v[96:99], v15 offset:16384
ds_read_b64_tr_b16 v[104:105], v6 offset:38912
ds_read_b64_tr_b16 v[106:107], v6 offset:39424
v_mfma_f32_32x32x16_bf16 v[128:143], v[72:75], v[68:71], v[128:143]
ds_read_b128 v[100:103], v15 offset:20480
ds_read_b64_tr_b16 v[108:109], v7 offset:38912
ds_read_b64_tr_b16 v[110:111], v7 offset:39424
v_mfma_f32_32x32x16_bf16 v[144:159], v[76:79], v[64:67], v[144:159]
v_mfma_f32_32x32x16_bf16 v[160:175], v[76:79], v[68:71], v[160:175]
s_waitcnt lgkmcnt(0)
s_barrier
v_mfma_f32_32x32x16_bf16 v[112:127], v[88:91], v[80:83], v[112:127]
ds_read_b128 v[48:51], v12 offset:32768
ds_read_b64_tr_b16 v[56:57], v6 offset:0
v_mfma_f32_32x32x16_bf16 v[128:143], v[88:91], v[84:87], v[128:143]
ds_read_b64_tr_b16 v[58:59], v6 offset:512
ds_read_b128 v[52:55], v12 offset:36864
v_mfma_f32_32x32x16_bf16 v[144:159], v[92:95], v[80:83], v[144:159]
ds_read_b64_tr_b16 v[60:61], v7 offset:0
v_mfma_f32_32x32x16_bf16 v[160:175], v[92:95], v[84:87], v[160:175]
ds_read_b64_tr_b16 v[62:63], v7 offset:512
s_waitcnt lgkmcnt(6)
v_mfma_f32_32x32x16_bf16 v[112:127], v[104:107], v[96:99], v[112:127]
ds_read_b128 v[64:67], v13 offset:32768
ds_read_b64_tr_b16 v[72:73], v6 offset:2048
v_mfma_f32_32x32x16_bf16 v[128:143], v[104:107], v[100:103], v[128:143]
ds_read_b64_tr_b16 v[74:75], v6 offset:2560
ds_read_b128 v[68:71], v13 offset:36864
v_mfma_f32_32x32x16_bf16 v[144:159], v[108:111], v[96:99], v[144:159]
ds_read_b64_tr_b16 v[76:77], v7 offset:2048
v_mfma_f32_32x32x16_bf16 v[160:175], v[108:111], v[100:103], v[160:175]
ds_read_b64_tr_b16 v[78:79], v7 offset:2560
s_waitcnt lgkmcnt(6)
v_mfma_f32_32x32x16_bf16 v[112:127], v[56:59], v[48:51], v[112:127]
ds_read_b128 v[80:83], v14 offset:32768
ds_read_b64_tr_b16 v[88:89], v6 offset:4096
v_mfma_f32_32x32x16_bf16 v[128:143], v[56:59], v[52:55], v[128:143]
ds_read_b64_tr_b16 v[90:91], v6 offset:4608
ds_read_b128 v[84:87], v14 offset:36864
v_mfma_f32_32x32x16_bf16 v[144:159], v[60:63], v[48:51], v[144:159]
ds_read_b64_tr_b16 v[92:93], v7 offset:4096
v_mfma_f32_32x32x16_bf16 v[160:175], v[60:63], v[52:55], v[160:175]
ds_read_b64_tr_b16 v[94:95], v7 offset:4608
s_waitcnt lgkmcnt(6)
v_mfma_f32_32x32x16_bf16 v[112:127], v[72:75], v[64:67], v[112:127]
ds_read_b128 v[96:99], v15 offset:32768
ds_read_b64_tr_b16 v[104:105], v6 offset:6144
ds_read_b64_tr_b16 v[106:107], v6 offset:6656
v_mfma_f32_32x32x16_bf16 v[128:143], v[72:75], v[68:71], v[128:143]
ds_read_b128 v[100:103], v15 offset:36864
ds_read_b64_tr_b16 v[108:109], v7 offset:6144
ds_read_b64_tr_b16 v[110:111], v7 offset:6656
v_mfma_f32_32x32x16_bf16 v[144:159], v[76:79], v[64:67], v[144:159]
v_mfma_f32_32x32x16_bf16 v[160:175], v[76:79], v[68:71], v[160:175]
s_waitcnt lgkmcnt(6)
v_mfma_f32_32x32x16_bf16 v[112:127], v[88:91], v[80:83], v[112:127]
v_mfma_f32_32x32x16_bf16 v[128:143], v[88:91], v[84:87], v[128:143]
v_mfma_f32_32x32x16_bf16 v[144:159], v[92:95], v[80:83], v[144:159]
v_mfma_f32_32x32x16_bf16 v[160:175], v[92:95], v[84:87], v[160:175]
s_waitcnt lgkmcnt(0)
v_mfma_f32_32x32x16_bf16 v[112:127], v[104:107], v[96:99], v[112:127]
v_mfma_f32_32x32x16_bf16 v[128:143], v[104:107], v[100:103], v[128:143]
v_mfma_f32_32x32x16_bf16 v[144:159], v[108:111], v[96:99], v[144:159]
v_mfma_f32_32x32x16_bf16 v[160:175], v[108:111], v[100:103], v[160:175]
s_barrier
s_nop 7
s_nop 7
s_call_b64 s[8:9], L_geglu
s_add_u32 s36, s36, 4096
s_add_u32 s37, s37, 4096
s_barrier
ds_read_b128 v[48:51], v8 offset:0
ds_read_b64_tr_b16 v[56:57], v6 offset:16384
ds_read_b64_tr_b16 v[58:59], v6 offset:16896
ds_read_b128 v[52:55], v8 offset:4096
ds_read_b64_tr_b16 v[60:61], v7 offset:16384
ds_read_b64_tr_b16 v[62:63], v7 offset:16896
ds_read_b128 v[64:67], v9 offset:0
ds_read_b64_tr_b16 v[72:73], v6 offset:18432
ds_read_b64_tr_b16 v[74:75], v6 offset:18944
ds_read_b128 v[68:71], v9 offset:4096
ds_read_b64_tr_b16 v[76:77], v7 offset:18432
ds_read_b64_tr_b16 v[78:79], v7 offset:18944
s_waitcnt lgkmcnt(6)
v_mfma_f32_32x32x16_bf16 v[112:127], v[56:59], v[48:51], 0
ds_read_b128 v[80:83], v10 offset:0
ds_read_b64_tr_b16 v[88:89], v6 offset:20480
v_mfma_f32_32x32x16_bf16 v[128:143], v[56:59], v[52:55], 0
ds_read_b64_tr_b16 v[90:91], v6 offset:20992
ds_read_b128 v[84:87], v10 offset:4096
v_mfma_f32_32x32x16_bf16 v[144:159], v[60:63], v[48:51], 0
ds_read_b64_tr_b16 v[92:93], v7 offset:20480
v_mfma_f32_32x32x16_bf16 v[160:175], v[60:63], v[52:55], 0
ds_read_b64_tr_b16 v[94:95], v7 offset:20992
s_waitcnt lgkmcnt(6)
v_mfma_f32_32x32x16_bf16 v[112:127], v[72:75], v[64:67], v[112:127]
ds_read_b128 v[96:99], v11 offset:0
ds_read_b64_tr_b16 v[104:105], v6 offset:22528
ds_read_b64_tr_b16 v[106:107], v6 offset:23040
v_mfma_f32_32x32x16_bf16 v[128:143], v[72:75], v[68:71], v[128:143]
ds_read_b128 v[100:103], v11 offset:4096
ds_read_b64_tr_b16 v[108:109], v7 offset:22528
ds_read_b64_tr_b16 v[110:111], v7 offset:23040
v_mfma_f32_32x32x16_bf16 v[144:159], v[76:79], v[64:67], v[144:159]
v_mfma_f32_32x32x16_bf16 v[160:175], v[76:79], v[68:71], v[160:175]
s_waitcnt lgkmcnt(0)
s_barrier
v_mfma_f32_32x32x16_bf16 v[112:127], v[88:91], v[80:83], v[112:127]
ds_read_b128 v[48:51], v8 offset:16384
ds_read_b64_tr_b16 v[56:57], v6 offset:32768
v_mfma_f32_32x32x16_bf16 v[128:143], v[88:91], v[84:87], v[128:143]
ds_read_b64_tr_b16 v[58:59], v6 offset:33280
ds_read_b128 v[52:55], v8 offset:20480
v_mfma_f32_32x32x16_bf16 v[144:159], v[92:95], v[80:83], v[144:159]
ds_read_b64_tr_b16 v[60:61], v7 offset:32768
v_mfma_f32_32x32x16_bf16 v[160:175], v[92:95], v[84:87], v[160:175]
ds_read_b64_tr_b16 v[62:63], v7 offset:33280
s_waitcnt lgkmcnt(6)
v_mfma_f32_32x32x16_bf16 v[112:127], v[104:107], v[96:99], v[112:127]
ds_read_b128 v[64:67], v9 offset:16384
ds_read_b64_tr_b16 v[72:73], v6 offset:34816
v_mfma_f32_32x32x16_bf16 v[128:143], v[104:107], v[100:103], v[128:143]
ds_read_b64_tr_b16 v[74:75], v6 offset:35328
ds_read_b128 v[68:71], v9 offset:20480
v_mfma_f32_32x32x16_bf16 v[144:159], v[108:111], v[96:99], v[144:159]
ds_read_b64_tr_b16 v[76:77], v7 offset:34816
v_mfma_f32_32x32x16_bf16 v[160:175], v[108:111], v[100:103], v[160:175]
ds_read_b64_tr_b16 v[78:79], v7 offset:35328
s_waitcnt lgkmcnt(6)
v_mfma_f32_32x32x16_bf16 v[112:127], v[56:59], v[48:51], v[112:127]
ds_read_b128 v[80:83], v10 offset:16384
ds_read_b64_tr_b16 v[88:89], v6 offset:36864
v_mfma_f32_32x32x16_bf16 v[128:143], v[56:59], v[52:55], v[128:143]
ds_read_b64_tr_b16 v[90:91], v6 offset:37376
ds_read_b128 v[84:87], v10 offset:20480
v_mfma_f32_32x32x16_bf16 v[144:159], v[60:63], v[48:51], v[144:159]
ds_read_b64_tr_b16 v[92:93], v7 offset:36864
v_mfma_f32_32x32x16_bf16 v[160:175], v[60:63], v[52:55], v[160:175]
ds_read_b64_tr_b16 v[94:95], v7 offset:37376
s_waitcnt lgkmcnt(6)
v_mfma_f32_32x32x16_bf16 v[112:127], v[72:75], v[64:67], v[112:127]
ds_read_b128 v[96:99], v11 offset:16384
ds_read_b64_tr_b16 v[104:105], v6 offset:38912
ds_read_b64_tr_b16 v[106:107], v6 offset:39424
v_mfma_f32_32x32x16_bf16 v[128:143], v[72:75], v[68:71], v[128:143]
ds_read_b128 v[100:103], v11 offset:20480
ds_read_b64_tr_b16 v[108:109], v7 offset:38912
ds_read_b64_tr_b16 v[110:111], v7 offset:39424
v_mfma_f32_32x32x16_bf16 v[144:159], v[76:79], v[64:67], v[144:159]
v_mfma_f32_32x32x16_bf16 v[160:175], v[76:79], v[68:71], v[160:175]
s_waitcnt vmcnt(0) lgkmcnt(0)
s_barrier
v_mfma_f32_32x32x16_bf16 v[112:127], v[88:91], v[80:83], v[112:127]
ds_read_b128 v[48:51], v8 offset:32768
ds_read_b64_tr_b16 v[56:57], v6 offset:0
v_mfma_f32_32x32x16_bf16 v[128:143], v[88:91], v[84:87], v[128:143]
ds_read_b64_tr_b16 v[58:59], v6 offset:512
ds_read_b128 v[52:55], v8 offset:36864
v_mfma_f32_32x32x16_bf16 v[144:159], v[92:95], v[80:83], v[144:159]
ds_read_b64_tr_b16 v[60:61], v7 offset:0
v_mfma_f32_32x32x16_bf16 v[160:175], v[92:95], v[84:87], v[160:175]
ds_read_b64_tr_b16 v[62:63], v7 offset:512
s_waitcnt lgkmcnt(6)
v_mfma_f32_32x32x16_bf16 v[112:127], v[104:107], v[96:99], v[112:127]
ds_read_b128 v[64:67], v9 offset:32768
ds_read_b64_tr_b16 v[72:73], v6 offset:2048
v_mfma_f32_32x32x16_bf16 v[128:143], v[104:107], v[100:103], v[128:143]
ds_read_b64_tr_b16 v[74:75], v6 offset:2560
ds_read_b128 v[68:71], v9 offset:36864
v_mfma_f32_32x32x16_bf16 v[144:159], v[108:111], v[96:99], v[144:159]
ds_read_b64_tr_b16 v[76:77], v7 offset:2048
v_mfma_f32_32x32x16_bf16 v[160:175], v[108:111], v[100:103], v[160:175]
ds_read_b64_tr_b16 v[78:79], v7 offset:2560
s_waitcnt lgkmcnt(6)
v_mfma_f32_32x32x16_bf16 v[112:127], v[56:59], v[48:51], v[112:127]
ds_read_b128 v[80:83], v10 offset:32768
ds_read_b64_tr_b16 v[88:89], v6 offset:4096
v_mfma_f32_32x32x16_bf16 v[128:143], v[56:59], v[52:55], v[128:143]
ds_read_b64_tr_b16 v[90:91], v6 offset:4608
ds_read_b128 v[84:87], v10 offset:36864
v_mfma_f32_32x32x16_bf16 v[144:159], v[60:63], v[48:51], v[144:159]
ds_read_b64_tr_b16 v[92:93], v7 offset:4096
v_mfma_f32_32x32x16_bf16 v[160:175], v[60:63], v[52:55], v[160:175]
ds_read_b64_tr_b16 v[94:95], v7 offset:4608
s_waitcnt lgkmcnt(6)
v_mfma_f32_32x32x16_bf16 v[112:127], v[72:75], v[64:67], v[112:127]
ds_read_b128 v[96:99], v11 offset:32768
ds_read_b64_tr_b16 v[104:105], v6 offset:6144
ds_read_b64_tr_b16 v[106:107], v6 offset:6656
v_mfma_f32_32x32x16_bf16 v[128:143], v[72:75], v[68:71], v[128:143]
ds_read_b128 v[100:103], v11 offset:36864
ds_read_b64_tr_b16 v[108:109], v7 offset:6144
ds_read_b64_tr_b16 v[110:111], v7 offset:6656
v_mfma_f32_32x32x16_bf16 v[144:159], v[76:79], v[64:67], v[144:159]
v_mfma_f32_32x32x16_bf16 v[160:175], v[76:79], v[68:71], v[160:175]
s_waitcnt lgkmcnt(0)
s_barrier
v_mfma_f32_32x32x16_bf16 v[112:127], v[88:91], v[80:83], v[112:127]
ds_read_b128 v[48:51], v8 offset:49152
ds_read_b64_tr_b16 v[56:57], v6 offset:16384
v_mfma_f32_32x32x16_bf16 v[128:143], v[88:91], v[84:87], v[128:143]
ds_read_b64_tr_b16 v[58:59], v6 offset:16896
ds_read_b128 v[52:55], v8 offset:53248
v_mfma_f32_32x32x16_bf16 v[144:159], v[92:95], v[80:83], v[144:159]
ds_read_b64_tr_b16 v[60:61], v7 offset:16384
v_mfma_f32_32x32x16_bf16 v[160:175], v[92:95], v[84:87], v[160:175]
ds_read_b64_tr_b16 v[62:63], v7 offset:16896
s_waitcnt lgkmcnt(6)
v_mfma_f32_32x32x16_bf16 v[112:127], v[104:107], v[96:99], v[112:127]
ds_read_b128 v[64:67], v9 offset:49152
ds_read_b64_tr_b16 v[72:73], v6 offset:18432
v_mfma_f32_32x32x16_bf16 v[128:143], v[104:107], v[100:103], v[128:143]
ds_read_b64_tr_b16 v[74:75], v6 offset:18944
ds_read_b128 v[68:71], v9 offset:53248
v_mfma_f32_32x32x16_bf16 v[144:159], v[108:111], v[96:99], v[144:159]
ds_read_b64_tr_b16 v[76:77], v7 offset:18432
v_mfma_f32_32x32x16_bf16 v[160:175], v[108:111], v[100:103], v[160:175]
ds_read_b64_tr_b16 v[78:79], v7 offset:18944
s_waitcnt lgkmcnt(6)
v_mfma_f32_32x32x16_bf16 v[112:127], v[56:59], v[48:51], v[112:127]
ds_read_b128 v[80:83], v10 offset:49152
ds_read_b64_tr_b16 v[88:89], v6 offset:20480
v_mfma_f32_32x32x16_bf16 v[128:143], v[56:59], v[52:55], v[128:143]
ds_read_b64_tr_b16 v[90:91], v6 offset:20992
ds_read_b128 v[84:87], v10 offset:53248
v_mfma_f32_32x32x16_bf16 v[144:159], v[60:63], v[48:51], v[144:159]
ds_read_b64_tr_b16 v[92:93], v7 offset:20480
v_mfma_f32_32x32x16_bf16 v[160:175], v[60:63], v[52:55], v[160:175]
ds_read_b64_tr_b16 v[94:95], v7 offset:20992
s_waitcnt lgkmcnt(6)
v_mfma_f32_32x32x16_bf16 v[112:127], v[72:75], v[64:67], v[112:127]
ds_read_b128 v[96:99], v11 offset:49152
ds_read_b64_tr_b16 v[104:105], v6 offset:22528
ds_read_b64_tr_b16 v[106:107], v6 offset:23040
v_mfma_f32_32x32x16_bf16 v[128:143], v[72:75], v[68:71], v[128:143]
ds_read_b128 v[100:103], v11 offset:53248
ds_read_b64_tr_b16 v[108:109], v7 offset:22528
ds_read_b64_tr_b16 v[110:111], v7 offset:23040
v_mfma_f32_32x32x16_bf16 v[144:159], v[76:79], v[64:67], v[144:159]
v_mfma_f32_32x32x16_bf16 v[160:175], v[76:79], v[68:71], v[160:175]
s_waitcnt lgkmcnt(0)
s_barrier
v_mfma_f32_32x32x16_bf16 v[112:127], v[88:91], v[80:83], v[112:127]
ds_read_b128 v[48:51], v12 offset:0
ds_read_b64_tr_b16 v[56:57], v6 offset:32768
v_mfma_f32_32x32x16_bf16 v[128:143], v[88:91], v[84:87], v[128:143]
ds_read_b64_tr_b16 v[58:59], v6 offset:33280
ds_read_b128 v[52:55], v12 offset:4096
v_mfma_f32_32x32x16_bf16 v[144:159], v[92:95], v[80:83], v[144:159]
ds_read_b64_tr_b16 v[60:61], v7 offset:32768
v_mfma_f32_32x32x16_bf16 v[160:175], v[92:95], v[84:87], v[160:175]
ds_read_b64_tr_b16 v[62:63], v7 offset:33280
s_waitcnt lgkmcnt(6)
v_mfma_f32_32x32x16_bf16 v[112:127], v[104:107], v[96:99], v[112:127]
ds_read_b128 v[64:67], v13 offset:0
ds_read_b64_tr_b16 v[72:73], v6 offset:34816
v_mfma_f32_32x32x16_bf16 v[128:143], v[104:107], v[100:103], v[128:143]
ds_read_b64_tr_b16 v[74:75], v6 offset:35328
ds_read_b128 v[68:71], v13 offset:4096
v_mfma_f32_32x32x16_bf16 v[144:159], v[108:111], v[96:99], v[144:159]
ds_read_b64_tr_b16 v[76:77], v7 offset:34816
v_mfma_f32_32x32x16_bf16 v[160:175], v[108:111], v[100:103], v[160:175]
ds_read_b64_tr_b16 v[78:79], v7 offset:35328
s_waitcnt lgkmcnt(6)
v_mfma_f32_32x32x16_bf16 v[112:127], v[56:59], v[48:51], v[112:127]
ds_read_b128 v[80:83], v14 offset:0
ds_read_b64_tr_b16 v[88:89], v6 offset:36864
v_mfma_f32_32x32x16_bf16 v[128:143], v[56:59], v[52:55], v[128:143]
ds_read_b64_tr_b16 v[90:91], v6 offset:37376
ds_read_b128 v[84:87], v14 offset:4096
v_mfma_f32_32x32x16_bf16 v[144:159], v[60:63], v[48:51], v[144:159]
ds_read_b64_tr_b16 v[92:93], v7 offset:36864
v_mfma_f32_32x32x16_bf16 v[160:175], v[60:63], v[52:55], v[160:175]
ds_read_b64_tr_b16 v[94:95], v7 offset:37376
buffer_load_dwordx2 v[40:41], v3, s[24:27], 0 offen sc1
s_waitcnt lgkmcnt(6)
v_mfma_f32_32x32x16_bf16 v[112:127], v[72:75], v[64:67], v[112:127]
ds_read_b128 v[96:99], v15 offset:0
ds_read_b64_tr_b16 v[104:105], v6 offset:38912
ds_read_b64_tr_b16 v[106:107], v6 offset:39424
v_mfma_f32_32x32x16_bf16 v[128:143], v[72:75], v[68:71], v[128:143]
ds_read_b128 v[100:103], v15 offset:4096
ds_read_b64_tr_b16 v[108:109], v7 offset:38912
ds_read_b64_tr_b16 v[110:111], v7 offset:39424
v_mfma_f32_32x32x16_bf16 v[144:159], v[76:79], v[64:67], v[144:159]
v_mfma_f32_32x32x16_bf16 v[160:175], v[76:79], v[68:71], v[160:175]
s_waitcnt lgkmcnt(0)
s_barrier
v_mfma_f32_32x32x16_bf16 v[112:127], v[88:91], v[80:83], v[112:127]
ds_read_b128 v[48:51], v12 offset:16384
ds_read_b64_tr_b16 v[56:57], v6 offset:0
v_mfma_f32_32x32x16_bf16 v[128:143], v[88:91], v[84:87], v[128:143]
ds_read_b64_tr_b16 v[58:59], v6 offset:512
ds_read_b128 v[52:55], v12 offset:20480
v_mfma_f32_32x32x16_bf16 v[144:159], v[92:95], v[80:83], v[144:159]
ds_read_b64_tr_b16 v[60:61], v7 offset:0
v_mfma_f32_32x32x16_bf16 v[160:175], v[92:95], v[84:87], v[160:175]
ds_read_b64_tr_b16 v[62:63], v7 offset:512
s_waitcnt lgkmcnt(6)
v_mfma_f32_32x32x16_bf16 v[112:127], v[104:107], v[96:99], v[112:127]
ds_read_b128 v[64:67], v13 offset:16384
ds_read_b64_tr_b16 v[72:73], v6 offset:2048
v_mfma_f32_32x32x16_bf16 v[128:143], v[104:107], v[100:103], v[128:143]
ds_read_b64_tr_b16 v[74:75], v6 offset:2560
ds_read_b128 v[68:71], v13 offset:20480
v_mfma_f32_32x32x16_bf16 v[144:159], v[108:111], v[96:99], v[144:159]
ds_read_b64_tr_b16 v[76:77], v7 offset:2048
v_mfma_f32_32x32x16_bf16 v[160:175], v[108:111], v[100:103], v[160:175]
ds_read_b64_tr_b16 v[78:79], v7 offset:2560
s_waitcnt lgkmcnt(6)
v_mfma_f32_32x32x16_bf16 v[112:127], v[56:59], v[48:51], v[112:127]
ds_read_b128 v[80:83], v14 offset:16384
ds_read_b64_tr_b16 v[88:89], v6 offset:4096
v_mfma_f32_32x32x16_bf16 v[128:143], v[56:59], v[52:55], v[128:143]
ds_read_b64_tr_b16 v[90:91], v6 offset:4608
ds_read_b128 v[84:87], v14 offset:20480
v_mfma_f32_32x32x16_bf16 v[144:159], v[60:63], v[48:51], v[144:159]
ds_read_b64_tr_b16 v[92:93], v7 offset:4096
v_mfma_f32_32x32x16_bf16 v[160:175], v[60:63], v[52:55], v[160:175]
ds_read_b64_tr_b16 v[94:95], v7 offset:4608
s_waitcnt lgkmcnt(6)
v_mfma_f32_32x32x16_bf16 v[112:127], v[72:75], v[64:67], v[112:127]
ds_read_b128 v[96:99], v15 offset:16384
ds_read_b64_tr_b16 v[104:105], v6 offset:6144
ds_read_b64_tr_b16 v[106:107], v6 offset:6656
v_mfma_f32_32x32x16_bf16 v[128:143], v[72:75], v[68:71], v[128:143]
ds_read_b128 v[100:103], v15 offset:20480
ds_read_b64_tr_b16 v[108:109], v7 offset:6144
ds_read_b64_tr_b16 v[110:111], v7 offset:6656
v_mfma_f32_32x32x16_bf16 v[144:159], v[76:79], v[64:67], v[144:159]
v_mfma_f32_32x32x16_bf16 v[160:175], v[76:79], v[68:71], v[160:175]
s_waitcnt lgkmcnt(0)
s_barrier
v_mfma_f32_32x32x16_bf16 v[112:127], v[88:91], v[80:83], v[112:127]
ds_read_b128 v[48:51], v12 offset:32768
ds_read_b64_tr_b16 v[56:57], v6 offset:16384
v_mfma_f32_32x32x16_bf16 v[128:143], v[88:91], v[84:87], v[128:143]
ds_read_b64_tr_b16 v[58:59], v6 offset:16896
ds_read_b128 v[52:55], v12 offset:36864
v_mfma_f32_32x32x16_bf16 v[144:159], v[92:95], v[80:83], v[144:159]
ds_read_b64_tr_b16 v[60:61], v7 offset:16384
v_mfma_f32_32x32x16_bf16 v[160:175], v[92:95], v[84:87], v[160:175]
ds_read_b64_tr_b16 v[62:63], v7 offset:16896
buffer_load_dwordx4 v[176:179], v22, s[40:43], s60 offen offset:0 sc1
s_waitcnt lgkmcnt(6)
v_mfma_f32_32x32x16_bf16 v[112:127], v[104:107], v[96:99], v[112:127]
ds_read_b128 v[64:67], v13 offset:32768
ds_read_b64_tr_b16 v[72:73], v6 offset:18432
v_mfma_f32_32x32x16_bf16 v[128:143], v[104:107], v[100:103], v[128:143]
ds_read_b64_tr_b16 v[74:75], v6 offset:18944
ds_read_b128 v[68:71], v13 offset:36864
v_mfma_f32_32x32x16_bf16 v[144:159], v[108:111], v[96:99], v[144:159]
ds_read_b64_tr_b16 v[76:77], v7 offset:18432
v_mfma_f32_32x32x16_bf16 v[160:175], v[108:111], v[100:103], v[160:175]
ds_read_b64_tr_b16 v[78:79], v7 offset:18944
buffer_load_dwordx4 v[180:183], v22, s[40:43], s60 offen offset:1024 sc1
s_waitcnt lgkmcnt(6)
v_mfma_f32_32x32x16_bf16 v[112:127], v[56:59], v[48:51], v[112:127]
ds_read_b128 v[80:83], v14 offset:32768
ds_read_b64_tr_b16 v[88:89], v6 offset:20480
v_mfma_f32_32x32x16_bf16 v[128:143], v[56:59], v[52:55], v[128:143]
ds_read_b64_tr_b16 v[90:91], v6 offset:20992
ds_read_b128 v[84:87], v14 offset:36864
v_mfma_f32_32x32x16_bf16 v[144:159], v[60:63], v[48:51], v[144:159]
ds_read_b64_tr_b16 v[92:93], v7 offset:20480
v_mfma_f32_32x32x16_bf16 v[160:175], v[60:63], v[52:55], v[160:175]
ds_read_b64_tr_b16 v[94:95], v7 offset:20992
buffer_load_dwordx4 v[184:187], v22, s[40:43], s60 offen offset:2048 sc1
s_waitcnt lgkmcnt(6)
v_mfma_f32_32x32x16_bf16 v[112:127], v[72:75], v[64:67], v[112:127]
ds_read_b128 v[96:99], v15 offset:32768
ds_read_b64_tr_b16 v[104:105], v6 offset:22528
ds_read_b64_tr_b16 v[106:107], v6 offset:23040
v_mfma_f32_32x32x16_bf16 v[128:143], v[72:75], v[68:71], v[128:143]
ds_read_b128 v[100:103], v15 offset:36864
ds_read_b64_tr_b16 v[108:109], v7 offset:22528
ds_read_b64_tr_b16 v[110:111], v7 offset:23040
v_mfma_f32_32x32x16_bf16 v[144:159], v[76:79], v[64:67], v[144:159]
v_mfma_f32_32x32x16_bf16 v[160:175], v[76:79], v[68:71], v[160:175]
buffer_load_dwordx4 v[188:191], v22, s[40:43], s60 offen offset:3072 sc1
s_waitcnt lgkmcnt(0)
s_barrier
v_mfma_f32_32x32x16_bf16 v[112:127], v[88:91], v[80:83], v[112:127]
v_mfma_f32_32x32x16_bf16 v[128:143], v[88:91], v[84:87], v[128:143]
v_mfma_f32_32x32x16_bf16 v[144:159], v[92:95], v[80:83], v[144:159]
v_mfma_f32_32x32x16_bf16 v[160:175], v[92:95], v[84:87], v[160:175]
s_waitcnt lgkmcnt(0)
v_mfma_f32_32x32x16_bf16 v[112:127], v[104:107], v[96:99], v[112:127]
v_mfma_f32_32x32x16_bf16 v[128:143], v[104:107], v[100:103], v[128:143]
v_mfma_f32_32x32x16_bf16 v[144:159], v[108:111], v[96:99], v[144:159]
v_mfma_f32_32x32x16_bf16 v[160:175], v[108:111], v[100:103], v[160:175]
    s_waitcnt vmcnt(4)
    s_mov_b32 s28, 0
L_c_nonce:
    v_readfirstlane_b32 s30, v40
    v_readfirstlane_b32 s31, v41
    s_add_u32 s28, s28, 1
    s_nop 3
    s_or_b32 s29, s30, s31
    s_cmp_lg_u32 s29, 0
    s_cbranch_scc1 L_c_havenonce
    s_cmp_gt_u32 s28, 16384
    s_cbranch_scc1 L_c_havenonce
    buffer_load_dwordx2 v[40:41], v3, s[24:27], 0 offen sc1
    s_waitcnt vmcnt(0)
    s_branch L_c_nonce
L_c_havenonce:

s_nop 7
s_call_b64 s[8:9], L_geglu
s_barrier
        s_lshl_b32 s56, s18, 12
        s_add_u32 s56, s56, s33
        v_add_u32 v8, s56, v22
        s_xor_b32 s57, s18, 2
        s_lshl_b32 s57, s57, 12
        s_add_u32 s57, s57, s33
        v_add_u32 v9, s57, v22
        v_and_b32 v10, 31, v1
        s_lshl_b32 s56, s54, 6
        s_and_b32 s57, s18, 1
        s_lshl_b32 s57, s57, 5
        s_add_u32 s56, s56, s57
        v_add_u32 v10, s56, v10
        v_mul_u32_u24 v10, 896, v10
        v_lshrrev_b32 v11, 5, v1
        v_lshl_add_u32 v10, v11, 4, v10
        s_lshl_b32 s56, s55, 7
        s_lshr_b32 s57, s18, 1
        s_lshl_b32 s57, s57, 6
        s_add_u32 s56, s56, s57
        v_add_u32 v10, s56, v10

v_add_u32 v18, s48, v16
v_add_u32 v19, s48, v17
ds_read_b64_tr_b16 v[96:97], v18 offset:0
ds_read_b64_tr_b16 v[98:99], v18 offset:1024
ds_read_b64_tr_b16 v[100:101], v19 offset:0
ds_read_b64_tr_b16 v[102:103], v19 offset:1024
ds_read_b64_tr_b16 v[104:105], v18 offset:2048
ds_read_b64_tr_b16 v[106:107], v18 offset:3072
ds_read_b64_tr_b16 v[108:109], v19 offset:2048
ds_read_b64_tr_b16 v[110:111], v19 offset:3072
ds_read_b64_tr_b16 v[240:241], v18 offset:4096
ds_read_b64_tr_b16 v[242:243], v18 offset:5120
ds_read_b64_tr_b16 v[244:245], v19 offset:4096
ds_read_b64_tr_b16 v[246:247], v19 offset:5120
buffer_load_dwordx4 v[192:195], v22, s[40:43], s61 offen offset:0 sc1
buffer_load_dwordx4 v[196:199], v22, s[40:43], s61 offen offset:1024 sc1
buffer_load_dwordx4 v[200:203], v22, s[40:43], s61 offen offset:2048 sc1
buffer_load_dwordx4 v[204:207], v22, s[40:43], s61 offen offset:3072 sc1
s_waitcnt vmcnt(11) lgkmcnt(8)
v_mfma_f32_32x32x16_bf16 v[112:127], v[96:99], v[176:179], 0
ds_read_b64_tr_b16 v[248:249], v18 offset:6144
ds_read_b64_tr_b16 v[250:251], v18 offset:7168
v_mfma_f32_32x32x16_bf16 v[128:143], v[100:103], v[176:179], 0
ds_read_b64_tr_b16 v[252:253], v19 offset:6144
ds_read_b64_tr_b16 v[254:255], v19 offset:7168
buffer_load_dwordx4 v[208:211], v22, s[40:43], s62 offen offset:0 sc1
buffer_load_dwordx4 v[212:215], v22, s[40:43], s62 offen offset:1024 sc1
buffer_load_dwordx4 v[216:219], v22, s[40:43], s62 offen offset:2048 sc1
s_waitcnt vmcnt(13) lgkmcnt(8)
v_mfma_f32_32x32x16_bf16 v[112:127], v[104:107], v[180:183], v[112:127]
v_add_u32 v20, s49, v16
v_add_u32 v21, s49, v17
ds_read_b64_tr_b16 v[96:97], v20 offset:0
ds_read_b64_tr_b16 v[98:99], v20 offset:1024
v_mfma_f32_32x32x16_bf16 v[128:143], v[108:111], v[180:183], v[128:143]
ds_read_b64_tr_b16 v[100:101], v21 offset:0
ds_read_b64_tr_b16 v[102:103], v21 offset:1024
buffer_load_dwordx4 v[220:223], v22, s[40:43], s62 offen offset:3072 sc1
buffer_load_dwordx4 v[224:227], v22, s[40:43], s63 offen offset:0 sc1
buffer_load_dwordx4 v[228:231], v22, s[40:43], s63 offen offset:1024 sc1
s_waitcnt vmcnt(15) lgkmcnt(8)
v_mfma_f32_32x32x16_bf16 v[112:127], v[240:243], v[184:187], v[112:127]
ds_read_b64_tr_b16 v[104:105], v20 offset:2048
ds_read_b64_tr_b16 v[106:107], v20 offset:3072
v_mfma_f32_32x32x16_bf16 v[128:143], v[244:247], v[184:187], v[128:143]
ds_read_b64_tr_b16 v[108:109], v21 offset:2048
ds_read_b64_tr_b16 v[110:111], v21 offset:3072
buffer_load_dwordx4 v[232:235], v22, s[40:43], s63 offen offset:2048 sc1
buffer_load_dwordx4 v[236:239], v22, s[40:43], s63 offen offset:3072 sc1
buffer_load_dwordx4 v[48:51], v22, s[40:43], s64 offen offset:0 sc1
s_waitcnt vmcnt(17) lgkmcnt(8)
v_mfma_f32_32x32x16_bf16 v[112:127], v[248:251], v[188:191], v[112:127]
ds_read_b64_tr_b16 v[240:241], v20 offset:4096
ds_read_b64_tr_b16 v[242:243], v20 offset:5120
v_mfma_f32_32x32x16_bf16 v[128:143], v[252:255], v[188:191], v[128:143]
ds_read_b64_tr_b16 v[244:245], v21 offset:4096
ds_read_b64_tr_b16 v[246:247], v21 offset:5120
buffer_load_dwordx4 v[52:55], v22, s[40:43], s64 offen offset:1024 sc1
buffer_load_dwordx4 v[56:59], v22, s[40:43], s64 offen offset:2048 sc1
buffer_load_dwordx4 v[60:63], v22, s[40:43], s64 offen offset:3072 sc1
s_waitcnt vmcnt(16)
    v_mov_b32 v42, s30
    v_mov_b32 v43, s31
    s_mov_b64 exec, 1
    buffer_store_dwordx2 v[42:43], v3, s[40:43], s21 offen sc1
    s_mov_b64 exec, -1

s_waitcnt vmcnt(16) lgkmcnt(8)
v_mfma_f32_32x32x16_bf16 v[112:127], v[96:99], v[192:195], v[112:127]
ds_read_b64_tr_b16 v[248:249], v20 offset:6144
ds_read_b64_tr_b16 v[250:251], v20 offset:7168
v_mfma_f32_32x32x16_bf16 v[128:143], v[100:103], v[192:195], v[128:143]
ds_read_b64_tr_b16 v[252:253], v21 offset:6144
ds_read_b64_tr_b16 v[254:255], v21 offset:7168
buffer_load_dwordx4 v[64:67], v22, s[40:43], s65 offen offset:0 sc1
buffer_load_dwordx4 v[68:71], v22, s[40:43], s65 offen offset:1024 sc1
buffer_load_dwordx4 v[72:75], v22, s[40:43], s65 offen offset:2048 sc1
s_waitcnt vmcnt(18) lgkmcnt(8)
v_mfma_f32_32x32x16_bf16 v[112:127], v[104:107], v[196:199], v[112:127]
v_add_u32 v18, s50, v16
v_add_u32 v19, s50, v17
ds_read_b64_tr_b16 v[96:97], v18 offset:0
ds_read_b64_tr_b16 v[98:99], v18 offset:1024
v_mfma_f32_32x32x16_bf16 v[128:143], v[108:111], v[196:199], v[128:143]
ds_read_b64_tr_b16 v[100:101], v19 offset:0
ds_read_b64_tr_b16 v[102:103], v19 offset:1024
buffer_load_dwordx4 v[76:79], v22, s[40:43], s65 offen offset:3072 sc1
buffer_load_dwordx4 v[80:83], v22, s[40:43], s66 offen offset:0 sc1
buffer_load_dwordx4 v[84:87], v22, s[40:43], s66 offen offset:1024 sc1
s_waitcnt vmcnt(20) lgkmcnt(8)
v_mfma_f32_32x32x16_bf16 v[112:127], v[240:243], v[200:203], v[112:127]
ds_read_b64_tr_b16 v[104:105], v18 offset:2048
ds_read_b64_tr_b16 v[106:107], v18 offset:3072
v_mfma_f32_32x32x16_bf16 v[128:143], v[244:247], v[200:203], v[128:143]
ds_read_b64_tr_b16 v[108:109], v19 offset:2048
ds_read_b64_tr_b16 v[110:111], v19 offset:3072
buffer_load_dwordx4 v[88:91], v22, s[40:43], s66 offen offset:2048 sc1
buffer_load_dwordx4 v[92:95], v22, s[40:43], s66 offen offset:3072 sc1
s_waitcnt vmcnt(21) lgkmcnt(8)
v_mfma_f32_32x32x16_bf16 v[112:127], v[248:251], v[204:207], v[112:127]
ds_read_b64_tr_b16 v[240:241], v18 offset:4096
ds_read_b64_tr_b16 v[242:243], v18 offset:5120
v_mfma_f32_32x32x16_bf16 v[128:143], v[252:255], v[204:207], v[128:143]
ds_read_b64_tr_b16 v[244:245], v19 offset:4096
ds_read_b64_tr_b16 v[246:247], v19 offset:5120
s_waitcnt vmcnt(20) lgkmcnt(8)
v_mfma_f32_32x32x16_bf16 v[112:127], v[96:99], v[208:211], v[112:127]
ds_read_b64_tr_b16 v[248:249], v18 offset:6144
ds_read_b64_tr_b16 v[250:251], v18 offset:7168
v_mfma_f32_32x32x16_bf16 v[128:143], v[100:103], v[208:211], v[128:143]
ds_read_b64_tr_b16 v[252:253], v19 offset:6144
ds_read_b64_tr_b16 v[254:255], v19 offset:7168
s_waitcnt vmcnt(19) lgkmcnt(8)
v_mfma_f32_32x32x16_bf16 v[112:127], v[104:107], v[212:215], v[112:127]
v_add_u32 v20, s51, v16
v_add_u32 v21, s51, v17
ds_read_b64_tr_b16 v[96:97], v20 offset:0
ds_read_b64_tr_b16 v[98:99], v20 offset:1024
v_mfma_f32_32x32x16_bf16 v[128:143], v[108:111], v[212:215], v[128:143]
ds_read_b64_tr_b16 v[100:101], v21 offset:0
ds_read_b64_tr_b16 v[102:103], v21 offset:1024
s_waitcnt vmcnt(18) lgkmcnt(8)
v_mfma_f32_32x32x16_bf16 v[112:127], v[240:243], v[216:219], v[112:127]
ds_read_b64_tr_b16 v[104:105], v20 offset:2048
ds_read_b64_tr_b16 v[106:107], v20 offset:3072
v_mfma_f32_32x32x16_bf16 v[128:143], v[244:247], v[216:219], v[128:143]
ds_read_b64_tr_b16 v[108:109], v21 offset:2048
ds_read_b64_tr_b16 v[110:111], v21 offset:3072
s_waitcnt vmcnt(17) lgkmcnt(8)
v_mfma_f32_32x32x16_bf16 v[112:127], v[248:251], v[220:223], v[112:127]
ds_read_b64_tr_b16 v[240:241], v20 offset:4096
ds_read_b64_tr_b16 v[242:243], v20 offset:5120
v_mfma_f32_32x32x16_bf16 v[128:143], v[252:255], v[220:223], v[128:143]
ds_read_b64_tr_b16 v[244:245], v21 offset:4096
ds_read_b64_tr_b16 v[246:247], v21 offset:5120
s_waitcnt vmcnt(16) lgkmcnt(8)
v_mfma_f32_32x32x16_bf16 v[112:127], v[96:99], v[224:227], v[112:127]
ds_read_b64_tr_b16 v[248:249], v20 offset:6144
ds_read_b64_tr_b16 v[250:251], v20 offset:7168
v_mfma_f32_32x32x16_bf16 v[128:143], v[100:103], v[224:227], v[128:143]
ds_read_b64_tr_b16 v[252:253], v21 offset:6144
ds_read_b64_tr_b16 v[254:255], v21 offset:7168
s_waitcnt vmcnt(15) lgkmcnt(8)
v_mfma_f32_32x32x16_bf16 v[112:127], v[104:107], v[228:231], v[112:127]
v_add_u32 v18, s33, v16
v_add_u32 v19, s33, v17
ds_read_b64_tr_b16 v[96:97], v18 offset:0
ds_read_b64_tr_b16 v[98:99], v18 offset:1024
v_mfma_f32_32x32x16_bf16 v[128:143], v[108:111], v[228:231], v[128:143]
ds_read_b64_tr_b16 v[100:101], v19 offset:0
ds_read_b64_tr_b16 v[102:103], v19 offset:1024
s_waitcnt vmcnt(14) lgkmcnt(8)
v_mfma_f32_32x32x16_bf16 v[112:127], v[240:243], v[232:235], v[112:127]
ds_read_b64_tr_b16 v[104:105], v18 offset:2048
ds_read_b64_tr_b16 v[106:107], v18 offset:3072
v_mfma_f32_32x32x16_bf16 v[128:143], v[244:247], v[232:235], v[128:143]
ds_read_b64_tr_b16 v[108:109], v19 offset:2048
ds_read_b64_tr_b16 v[110:111], v19 offset:3072
s_waitcnt vmcnt(13) lgkmcnt(8)
s_barrier
v_mfma_f32_32x32x16_bf16 v[112:127], v[248:251], v[236:239], v[112:127]
ds_read_b64_tr_b16 v[240:241], v18 offset:4096
ds_read_b64_tr_b16 v[242:243], v18 offset:5120
v_mfma_f32_32x32x16_bf16 v[128:143], v[252:255], v[236:239], v[128:143]
ds_read_b64_tr_b16 v[244:245], v19 offset:4096
ds_read_b64_tr_b16 v[246:247], v19 offset:5120
s_waitcnt vmcnt(12) lgkmcnt(8)
v_mfma_f32_32x32x16_bf16 v[112:127], v[96:99], v[48:51], v[112:127]
ds_read_b64_tr_b16 v[248:249], v18 offset:6144
ds_read_b64_tr_b16 v[250:251], v18 offset:7168
v_mfma_f32_32x32x16_bf16 v[128:143], v[100:103], v[48:51], v[128:143]
ds_read_b64_tr_b16 v[252:253], v19 offset:6144
ds_read_b64_tr_b16 v[254:255], v19 offset:7168
s_waitcnt vmcnt(11) lgkmcnt(8)
v_mfma_f32_32x32x16_bf16 v[112:127], v[104:107], v[52:55], v[112:127]
v_add_u32 v20, s34, v16
v_add_u32 v21, s34, v17
ds_read_b64_tr_b16 v[96:97], v20 offset:0
ds_read_b64_tr_b16 v[98:99], v20 offset:1024
v_mfma_f32_32x32x16_bf16 v[128:143], v[108:111], v[52:55], v[128:143]
ds_read_b64_tr_b16 v[100:101], v21 offset:0
ds_read_b64_tr_b16 v[102:103], v21 offset:1024
s_waitcnt vmcnt(10) lgkmcnt(8)
v_mfma_f32_32x32x16_bf16 v[112:127], v[240:243], v[56:59], v[112:127]
ds_read_b64_tr_b16 v[104:105], v20 offset:2048
ds_read_b64_tr_b16 v[106:107], v20 offset:3072
v_mfma_f32_32x32x16_bf16 v[128:143], v[244:247], v[56:59], v[128:143]
ds_read_b64_tr_b16 v[108:109], v21 offset:2048
ds_read_b64_tr_b16 v[110:111], v21 offset:3072
s_waitcnt vmcnt(9) lgkmcnt(8)
v_mfma_f32_32x32x16_bf16 v[112:127], v[248:251], v[60:63], v[112:127]
ds_read_b64_tr_b16 v[240:241], v20 offset:4096
ds_read_b64_tr_b16 v[242:243], v20 offset:5120
v_mfma_f32_32x32x16_bf16 v[128:143], v[252:255], v[60:63], v[128:143]
ds_read_b64_tr_b16 v[244:245], v21 offset:4096
ds_read_b64_tr_b16 v[246:247], v21 offset:5120
s_waitcnt vmcnt(7) lgkmcnt(8)
v_mfma_f32_32x32x16_bf16 v[112:127], v[96:99], v[64:67], v[112:127]
ds_read_b64_tr_b16 v[248:249], v20 offset:6144
ds_read_b64_tr_b16 v[250:251], v20 offset:7168
v_mfma_f32_32x32x16_bf16 v[128:143], v[100:103], v[64:67], v[128:143]
ds_read_b64_tr_b16 v[252:253], v21 offset:6144
ds_read_b64_tr_b16 v[254:255], v21 offset:7168
buffer_load_dwordx2 v[40:41], v2, s[40:43], s32 offen sc1
s_waitcnt vmcnt(7) lgkmcnt(8)
v_mfma_f32_32x32x16_bf16 v[112:127], v[104:107], v[68:71], v[112:127]
v_add_u32 v18, s35, v16
v_add_u32 v19, s35, v17
ds_read_b64_tr_b16 v[96:97], v18 offset:0
ds_read_b64_tr_b16 v[98:99], v18 offset:1024
v_mfma_f32_32x32x16_bf16 v[128:143], v[108:111], v[68:71], v[128:143]
ds_read_b64_tr_b16 v[100:101], v19 offset:0
ds_read_b64_tr_b16 v[102:103], v19 offset:1024
s_waitcnt vmcnt(6) lgkmcnt(8)
v_mfma_f32_32x32x16_bf16 v[112:127], v[240:243], v[72:75], v[112:127]
ds_read_b64_tr_b16 v[104:105], v18 offset:2048
ds_read_b64_tr_b16 v[106:107], v18 offset:3072
v_mfma_f32_32x32x16_bf16 v[128:143], v[244:247], v[72:75], v[128:143]
ds_read_b64_tr_b16 v[108:109], v19 offset:2048
ds_read_b64_tr_b16 v[110:111], v19 offset:3072
s_waitcnt vmcnt(5) lgkmcnt(8)
v_mfma_f32_32x32x16_bf16 v[112:127], v[248:251], v[76:79], v[112:127]
ds_read_b64_tr_b16 v[240:241], v18 offset:4096
ds_read_b64_tr_b16 v[242:243], v18 offset:5120
v_mfma_f32_32x32x16_bf16 v[128:143], v[252:255], v[76:79], v[128:143]
ds_read_b64_tr_b16 v[244:245], v19 offset:4096
ds_read_b64_tr_b16 v[246:247], v19 offset:5120
s_waitcnt vmcnt(4) lgkmcnt(8)
v_mfma_f32_32x32x16_bf16 v[112:127], v[96:99], v[80:83], v[112:127]
ds_read_b64_tr_b16 v[248:249], v18 offset:6144
ds_read_b64_tr_b16 v[250:251], v18 offset:7168
v_mfma_f32_32x32x16_bf16 v[128:143], v[100:103], v[80:83], v[128:143]
ds_read_b64_tr_b16 v[252:253], v19 offset:6144
ds_read_b64_tr_b16 v[254:255], v19 offset:7168
s_waitcnt vmcnt(3) lgkmcnt(8)
v_mfma_f32_32x32x16_bf16 v[112:127], v[104:107], v[84:87], v[112:127]
v_add_u32 v20, 114688, v16
v_add_u32 v21, 114688, v17
ds_read_b64_tr_b16 v[96:97], v20 offset:0
ds_read_b64_tr_b16 v[98:99], v20 offset:1024
v_mfma_f32_32x32x16_bf16 v[128:143], v[108:111], v[84:87], v[128:143]
ds_read_b64_tr_b16 v[100:101], v21 offset:0
ds_read_b64_tr_b16 v[102:103], v21 offset:1024
    s_waitcnt vmcnt(0)
    v_cmp_eq_u64 vcc, s[30:31], v[40:41]
    s_mov_b32 s28, 0
    s_nop 4
    s_and_b32 s29, vcc_lo, 0x3fff

    s_lshr_b32 s20, s29, 0
    s_and_b32 s20, s20, 3
    s_cmp_eq_u32 s20, 3
    s_cbranch_scc1 L_c_ok0
buffer_load_dwordx2 v[40:41], v2, s[40:43], s32 offen sc1
s_sleep 6
buffer_load_dwordx2 v[42:43], v2, s[40:43], s32 offen sc1
s_sleep 6
L_c_poll0:
    buffer_load_dwordx2 v[44:45], v2, s[40:43], s32 offen sc1
    s_waitcnt vmcnt(2)
    v_cmp_eq_u64 vcc, s[30:31], v[40:41]
    s_add_u32 s28, s28, 1
    s_nop 4
    s_and_b32 s29, vcc_lo, 0x3fff

    s_lshr_b32 s20, s29, 0
    s_and_b32 s20, s20, 3
    s_cmp_eq_u32 s20, 3

    s_cbranch_scc1 L_c_ok0

    buffer_load_dwordx2 v[40:41], v2, s[40:43], s32 offen sc1
    s_waitcnt vmcnt(2)
    v_cmp_eq_u64 vcc, s[30:31], v[42:43]
    s_add_u32 s28, s28, 1
    s_nop 4
    s_and_b32 s29, vcc_lo, 0x3fff

    s_lshr_b32 s20, s29, 0
    s_and_b32 s20, s20, 3
    s_cmp_eq_u32 s20, 3

    s_cbranch_scc1 L_c_ok0

    buffer_load_dwordx2 v[42:43], v2, s[40:43], s32 offen sc1
    s_waitcnt vmcnt(2)
    v_cmp_eq_u64 vcc, s[30:31], v[44:45]
    s_add_u32 s28, s28, 1
    s_nop 4
    s_and_b32 s29, vcc_lo, 0x3fff

    s_lshr_b32 s20, s29, 0
    s_and_b32 s20, s20, 3
    s_cmp_eq_u32 s20, 3

    s_cbranch_scc1 L_c_ok0

    s_cmp_gt_u32 s28, 16384
    s_cbranch_scc0 L_c_poll0

L_c_ok0:
s_add_u32 s60, s60, 4096
buffer_load_dwordx4 v[176:179], v22, s[40:43], s60 offen offset:0 sc1
buffer_load_dwordx4 v[180:183], v22, s[40:43], s60 offen offset:1024 sc1
buffer_load_dwordx4 v[184:187], v22, s[40:43], s60 offen offset:2048 sc1
buffer_load_dwordx4 v[188:191], v22, s[40:43], s60 offen offset:3072 sc1
s_waitcnt vmcnt(6) lgkmcnt(8)
v_mfma_f32_32x32x16_bf16 v[112:127], v[240:243], v[88:91], v[112:127]
ds_read_b64_tr_b16 v[104:105], v20 offset:2048
ds_read_b64_tr_b16 v[106:107], v20 offset:3072
v_mfma_f32_32x32x16_bf16 v[128:143], v[244:247], v[88:91], v[128:143]
ds_read_b64_tr_b16 v[108:109], v21 offset:2048
ds_read_b64_tr_b16 v[110:111], v21 offset:3072
    s_lshr_b32 s20, s29, 2
    s_and_b32 s20, s20, 3
    s_cmp_eq_u32 s20, 3
    s_cbranch_scc1 L_c_ok1
buffer_load_dwordx2 v[40:41], v2, s[40:43], s32 offen sc1
s_sleep 6
buffer_load_dwordx2 v[42:43], v2, s[40:43], s32 offen sc1
s_sleep 6
L_c_poll1:
    buffer_load_dwordx2 v[44:45], v2, s[40:43], s32 offen sc1
    s_waitcnt vmcnt(2)
    v_cmp_eq_u64 vcc, s[30:31], v[40:41]
    s_add_u32 s28, s28, 1
    s_nop 4
    s_and_b32 s29, vcc_lo, 0x3fff

    s_lshr_b32 s20, s29, 2
    s_and_b32 s20, s20, 3
    s_cmp_eq_u32 s20, 3

    s_cbranch_scc1 L_c_ok1

    buffer_load_dwordx2 v[40:41], v2, s[40:43], s32 offen sc1
    s_waitcnt vmcnt(2)
    v_cmp_eq_u64 vcc, s[30:31], v[42:43]
    s_add_u32 s28, s28, 1
    s_nop 4
    s_and_b32 s29, vcc_lo, 0x3fff

    s_lshr_b32 s20, s29, 2
    s_and_b32 s20, s20, 3
    s_cmp_eq_u32 s20, 3

    s_cbranch_scc1 L_c_ok1

    buffer_load_dwordx2 v[42:43], v2, s[40:43], s32 offen sc1
    s_waitcnt vmcnt(2)
    v_cmp_eq_u64 vcc, s[30:31], v[44:45]
    s_add_u32 s28, s28, 1
    s_nop 4
    s_and_b32 s29, vcc_lo, 0x3fff

    s_lshr_b32 s20, s29, 2
    s_and_b32 s20, s20, 3
    s_cmp_eq_u32 s20, 3

    s_cbranch_scc1 L_c_ok1

    s_cmp_gt_u32 s28, 16384
    s_cbranch_scc0 L_c_poll1

L_c_ok1:
s_add_u32 s61, s61, 4096
buffer_load_dwordx4 v[192:195], v22, s[40:43], s61 offen offset:0 sc1
buffer_load_dwordx4 v[196:199], v22, s[40:43], s61 offen offset:1024 sc1
buffer_load_dwordx4 v[200:203], v22, s[40:43], s61 offen offset:2048 sc1
buffer_load_dwordx4 v[204:207], v22, s[40:43], s61 offen offset:3072 sc1
s_waitcnt vmcnt(9) lgkmcnt(8)
v_mfma_f32_32x32x16_bf16 v[112:127], v[248:251], v[92:95], v[112:127]
ds_read_b64_tr_b16 v[240:241], v20 offset:4096
ds_read_b64_tr_b16 v[242:243], v20 offset:5120
v_mfma_f32_32x32x16_bf16 v[128:143], v[252:255], v[92:95], v[128:143]
ds_read_b64_tr_b16 v[244:245], v21 offset:4096
ds_read_b64_tr_b16 v[246:247], v21 offset:5120
    s_lshr_b32 s20, s29, 4
    s_and_b32 s20, s20, 3
    s_cmp_eq_u32 s20, 3
    s_cbranch_scc1 L_c_ok2
buffer_load_dwordx2 v[40:41], v2, s[40:43], s32 offen sc1
s_sleep 6
buffer_load_dwordx2 v[42:43], v2, s[40:43], s32 offen sc1
s_sleep 6
L_c_poll2:
    buffer_load_dwordx2 v[44:45], v2, s[40:43], s32 offen sc1
    s_waitcnt vmcnt(2)
    v_cmp_eq_u64 vcc, s[30:31], v[40:41]
    s_add_u32 s28, s28, 1
    s_nop 4
    s_and_b32 s29, vcc_lo, 0x3fff

    s_lshr_b32 s20, s29, 4
    s_and_b32 s20, s20, 3
    s_cmp_eq_u32 s20, 3

    s_cbranch_scc1 L_c_ok2

    buffer_load_dwordx2 v[40:41], v2, s[40:43], s32 offen sc1
    s_waitcnt vmcnt(2)
    v_cmp_eq_u64 vcc, s[30:31], v[42:43]
    s_add_u32 s28, s28, 1
    s_nop 4
    s_and_b32 s29, vcc_lo, 0x3fff

    s_lshr_b32 s20, s29, 4
    s_and_b32 s20, s20, 3
    s_cmp_eq_u32 s20, 3

    s_cbranch_scc1 L_c_ok2

    buffer_load_dwordx2 v[42:43], v2, s[40:43], s32 offen sc1
    s_waitcnt vmcnt(2)
    v_cmp_eq_u64 vcc, s[30:31], v[44:45]
    s_add_u32 s28, s28, 1
    s_nop 4
    s_and_b32 s29, vcc_lo, 0x3fff

    s_lshr_b32 s20, s29, 4
    s_and_b32 s20, s20, 3
    s_cmp_eq_u32 s20, 3

    s_cbranch_scc1 L_c_ok2

    s_cmp_gt_u32 s28, 16384
    s_cbranch_scc0 L_c_poll2

L_c_ok2:
s_add_u32 s62, s62, 4096
buffer_load_dwordx4 v[208:211], v22, s[40:43], s62 offen offset:0 sc1
buffer_load_dwordx4 v[212:215], v22, s[40:43], s62 offen offset:1024 sc1
buffer_load_dwordx4 v[216:219], v22, s[40:43], s62 offen offset:2048 sc1
buffer_load_dwordx4 v[220:223], v22, s[40:43], s62 offen offset:3072 sc1
s_waitcnt vmcnt(11) lgkmcnt(8)
v_mfma_f32_32x32x16_bf16 v[112:127], v[96:99], v[176:179], v[112:127]
ds_read_b64_tr_b16 v[248:249], v20 offset:6144
ds_read_b64_tr_b16 v[250:251], v20 offset:7168
v_mfma_f32_32x32x16_bf16 v[128:143], v[100:103], v[176:179], v[128:143]
ds_read_b64_tr_b16 v[252:253], v21 offset:6144
ds_read_b64_tr_b16 v[254:255], v21 offset:7168
s_waitcnt vmcnt(10) lgkmcnt(8)
v_mfma_f32_32x32x16_bf16 v[112:127], v[104:107], v[180:183], v[112:127]
v_add_u32 v18, 98304, v16
v_add_u32 v19, 98304, v17
ds_read_b64_tr_b16 v[96:97], v18 offset:0
ds_read_b64_tr_b16 v[98:99], v18 offset:1024
v_mfma_f32_32x32x16_bf16 v[128:143], v[108:111], v[180:183], v[128:143]
ds_read_b64_tr_b16 v[100:101], v19 offset:0
ds_read_b64_tr_b16 v[102:103], v19 offset:1024
s_waitcnt vmcnt(9) lgkmcnt(8)
v_mfma_f32_32x32x16_bf16 v[112:127], v[240:243], v[184:187], v[112:127]
ds_read_b64_tr_b16 v[104:105], v18 offset:2048
ds_read_b64_tr_b16 v[106:107], v18 offset:3072
v_mfma_f32_32x32x16_bf16 v[128:143], v[244:247], v[184:187], v[128:143]
ds_read_b64_tr_b16 v[108:109], v19 offset:2048
ds_read_b64_tr_b16 v[110:111], v19 offset:3072
    s_lshr_b32 s20, s29, 6
    s_and_b32 s20, s20, 3
    s_cmp_eq_u32 s20, 3
    s_cbranch_scc1 L_c_ok3
buffer_load_dwordx2 v[40:41], v2, s[40:43], s32 offen sc1
s_sleep 6
buffer_load_dwordx2 v[42:43], v2, s[40:43], s32 offen sc1
s_sleep 6
L_c_poll3:
    buffer_load_dwordx2 v[44:45], v2, s[40:43], s32 offen sc1
    s_waitcnt vmcnt(2)
    v_cmp_eq_u64 vcc, s[30:31], v[40:41]
    s_add_u32 s28, s28, 1
    s_nop 4
    s_and_b32 s29, vcc_lo, 0x3fff

    s_lshr_b32 s20, s29, 6
    s_and_b32 s20, s20, 3
    s_cmp_eq_u32 s20, 3

    s_cbranch_scc1 L_c_ok3

    buffer_load_dwordx2 v[40:41], v2, s[40:43], s32 offen sc1
    s_waitcnt vmcnt(2)
    v_cmp_eq_u64 vcc, s[30:31], v[42:43]
    s_add_u32 s28, s28, 1
    s_nop 4
    s_and_b32 s29, vcc_lo, 0x3fff

    s_lshr_b32 s20, s29, 6
    s_and_b32 s20, s20, 3
    s_cmp_eq_u32 s20, 3

    s_cbranch_scc1 L_c_ok3

    buffer_load_dwordx2 v[42:43], v2, s[40:43], s32 offen sc1
    s_waitcnt vmcnt(2)
    v_cmp_eq_u64 vcc, s[30:31], v[44:45]
    s_add_u32 s28, s28, 1
    s_nop 4
    s_and_b32 s29, vcc_lo, 0x3fff

    s_lshr_b32 s20, s29, 6
    s_and_b32 s20, s20, 3
    s_cmp_eq_u32 s20, 3

    s_cbranch_scc1 L_c_ok3

    s_cmp_gt_u32 s28, 16384
    s_cbranch_scc0 L_c_poll3

L_c_ok3:
s_add_u32 s63, s63, 4096
buffer_load_dwordx4 v[224:227], v22, s[40:43], s63 offen offset:0 sc1
buffer_load_dwordx4 v[228:231], v22, s[40:43], s63 offen offset:1024 sc1
buffer_load_dwordx4 v[232:235], v22, s[40:43], s63 offen offset:2048 sc1
buffer_load_dwordx4 v[236:239], v22, s[40:43], s63 offen offset:3072 sc1
s_waitcnt vmcnt(12) lgkmcnt(8)
v_mfma_f32_32x32x16_bf16 v[112:127], v[248:251], v[188:191], v[112:127]
ds_read_b64_tr_b16 v[240:241], v18 offset:4096
ds_read_b64_tr_b16 v[242:243], v18 offset:5120
v_mfma_f32_32x32x16_bf16 v[128:143], v[252:255], v[188:191], v[128:143]
ds_read_b64_tr_b16 v[244:245], v19 offset:4096
ds_read_b64_tr_b16 v[246:247], v19 offset:5120
s_waitcnt vmcnt(11) lgkmcnt(8)
v_mfma_f32_32x32x16_bf16 v[112:127], v[96:99], v[192:195], v[112:127]
ds_read_b64_tr_b16 v[248:249], v18 offset:6144
ds_read_b64_tr_b16 v[250:251], v18 offset:7168
v_mfma_f32_32x32x16_bf16 v[128:143], v[100:103], v[192:195], v[128:143]
ds_read_b64_tr_b16 v[252:253], v19 offset:6144
ds_read_b64_tr_b16 v[254:255], v19 offset:7168
s_waitcnt vmcnt(10) lgkmcnt(8)
v_mfma_f32_32x32x16_bf16 v[112:127], v[104:107], v[196:199], v[112:127]
v_add_u32 v20, 131072, v16
v_add_u32 v21, 131072, v17
ds_read_b64_tr_b16 v[96:97], v20 offset:0
ds_read_b64_tr_b16 v[98:99], v20 offset:1024
v_mfma_f32_32x32x16_bf16 v[128:143], v[108:111], v[196:199], v[128:143]
ds_read_b64_tr_b16 v[100:101], v21 offset:0
ds_read_b64_tr_b16 v[102:103], v21 offset:1024
    s_lshr_b32 s20, s29, 8
    s_and_b32 s20, s20, 3
    s_cmp_eq_u32 s20, 3
    s_cbranch_scc1 L_c_ok4
buffer_load_dwordx2 v[40:41], v2, s[40:43], s32 offen sc1
s_sleep 6
buffer_load_dwordx2 v[42:43], v2, s[40:43], s32 offen sc1
s_sleep 6
L_c_poll4:
    buffer_load_dwordx2 v[44:45], v2, s[40:43], s32 offen sc1
    s_waitcnt vmcnt(2)
    v_cmp_eq_u64 vcc, s[30:31], v[40:41]
    s_add_u32 s28, s28, 1
    s_nop 4
    s_and_b32 s29, vcc_lo, 0x3fff

    s_lshr_b32 s20, s29, 8
    s_and_b32 s20, s20, 3
    s_cmp_eq_u32 s20, 3

    s_cbranch_scc1 L_c_ok4

    buffer_load_dwordx2 v[40:41], v2, s[40:43], s32 offen sc1
    s_waitcnt vmcnt(2)
    v_cmp_eq_u64 vcc, s[30:31], v[42:43]
    s_add_u32 s28, s28, 1
    s_nop 4
    s_and_b32 s29, vcc_lo, 0x3fff

    s_lshr_b32 s20, s29, 8
    s_and_b32 s20, s20, 3
    s_cmp_eq_u32 s20, 3

    s_cbranch_scc1 L_c_ok4

    buffer_load_dwordx2 v[42:43], v2, s[40:43], s32 offen sc1
    s_waitcnt vmcnt(2)
    v_cmp_eq_u64 vcc, s[30:31], v[44:45]
    s_add_u32 s28, s28, 1
    s_nop 4
    s_and_b32 s29, vcc_lo, 0x3fff

    s_lshr_b32 s20, s29, 8
    s_and_b32 s20, s20, 3
    s_cmp_eq_u32 s20, 3

    s_cbranch_scc1 L_c_ok4

    s_cmp_gt_u32 s28, 16384
    s_cbranch_scc0 L_c_poll4

L_c_ok4:
s_add_u32 s64, s64, 4096
buffer_load_dwordx4 v[48:51], v22, s[40:43], s64 offen offset:0 sc1
buffer_load_dwordx4 v[52:55], v22, s[40:43], s64 offen offset:1024 sc1
buffer_load_dwordx4 v[56:59], v22, s[40:43], s64 offen offset:2048 sc1
buffer_load_dwordx4 v[60:63], v22, s[40:43], s64 offen offset:3072 sc1
s_waitcnt vmcnt(13) lgkmcnt(8)
v_mfma_f32_32x32x16_bf16 v[112:127], v[240:243], v[200:203], v[112:127]
ds_read_b64_tr_b16 v[104:105], v20 offset:2048
ds_read_b64_tr_b16 v[106:107], v20 offset:3072
v_mfma_f32_32x32x16_bf16 v[128:143], v[244:247], v[200:203], v[128:143]
ds_read_b64_tr_b16 v[108:109], v21 offset:2048
ds_read_b64_tr_b16 v[110:111], v21 offset:3072
s_waitcnt vmcnt(12) lgkmcnt(8)
v_mfma_f32_32x32x16_bf16 v[112:127], v[248:251], v[204:207], v[112:127]
ds_read_b64_tr_b16 v[240:241], v20 offset:4096
ds_read_b64_tr_b16 v[242:243], v20 offset:5120
v_mfma_f32_32x32x16_bf16 v[128:143], v[252:255], v[204:207], v[128:143]
ds_read_b64_tr_b16 v[244:245], v21 offset:4096
ds_read_b64_tr_b16 v[246:247], v21 offset:5120
s_waitcnt vmcnt(11) lgkmcnt(8)
v_mfma_f32_32x32x16_bf16 v[112:127], v[96:99], v[208:211], v[112:127]
ds_read_b64_tr_b16 v[248:249], v20 offset:6144
ds_read_b64_tr_b16 v[250:251], v20 offset:7168
v_mfma_f32_32x32x16_bf16 v[128:143], v[100:103], v[208:211], v[128:143]
ds_read_b64_tr_b16 v[252:253], v21 offset:6144
ds_read_b64_tr_b16 v[254:255], v21 offset:7168
s_waitcnt vmcnt(10) lgkmcnt(8)
s_barrier
v_mfma_f32_32x32x16_bf16 v[112:127], v[104:107], v[212:215], v[112:127]
v_add_u32 v18, s48, v16
v_add_u32 v19, s48, v17
ds_read_b64_tr_b16 v[96:97], v18 offset:0
ds_read_b64_tr_b16 v[98:99], v18 offset:1024
v_mfma_f32_32x32x16_bf16 v[128:143], v[108:111], v[212:215], v[128:143]
ds_read_b64_tr_b16 v[100:101], v19 offset:0
ds_read_b64_tr_b16 v[102:103], v19 offset:1024
    s_lshr_b32 s20, s29, 10
    s_and_b32 s20, s20, 3
    s_cmp_eq_u32 s20, 3
    s_cbranch_scc1 L_c_ok5
buffer_load_dwordx2 v[40:41], v2, s[40:43], s32 offen sc1
s_sleep 6
buffer_load_dwordx2 v[42:43], v2, s[40:43], s32 offen sc1
s_sleep 6
L_c_poll5:
    buffer_load_dwordx2 v[44:45], v2, s[40:43], s32 offen sc1
    s_waitcnt vmcnt(2)
    v_cmp_eq_u64 vcc, s[30:31], v[40:41]
    s_add_u32 s28, s28, 1
    s_nop 4
    s_and_b32 s29, vcc_lo, 0x3fff

    s_lshr_b32 s20, s29, 10
    s_and_b32 s20, s20, 3
    s_cmp_eq_u32 s20, 3

    s_cbranch_scc1 L_c_ok5

    buffer_load_dwordx2 v[40:41], v2, s[40:43], s32 offen sc1
    s_waitcnt vmcnt(2)
    v_cmp_eq_u64 vcc, s[30:31], v[42:43]
    s_add_u32 s28, s28, 1
    s_nop 4
    s_and_b32 s29, vcc_lo, 0x3fff

    s_lshr_b32 s20, s29, 10
    s_and_b32 s20, s20, 3
    s_cmp_eq_u32 s20, 3

    s_cbranch_scc1 L_c_ok5

    buffer_load_dwordx2 v[42:43], v2, s[40:43], s32 offen sc1
    s_waitcnt vmcnt(2)
    v_cmp_eq_u64 vcc, s[30:31], v[44:45]
    s_add_u32 s28, s28, 1
    s_nop 4
    s_and_b32 s29, vcc_lo, 0x3fff

    s_lshr_b32 s20, s29, 10
    s_and_b32 s20, s20, 3
    s_cmp_eq_u32 s20, 3

    s_cbranch_scc1 L_c_ok5

    s_cmp_gt_u32 s28, 16384
    s_cbranch_scc0 L_c_poll5

L_c_ok5:
s_add_u32 s65, s65, 4096
buffer_load_dwordx4 v[64:67], v22, s[40:43], s65 offen offset:0 sc1
buffer_load_dwordx4 v[68:71], v22, s[40:43], s65 offen offset:1024 sc1
buffer_load_dwordx4 v[72:75], v22, s[40:43], s65 offen offset:2048 sc1
buffer_load_dwordx4 v[76:79], v22, s[40:43], s65 offen offset:3072 sc1
s_waitcnt vmcnt(13) lgkmcnt(8)
v_mfma_f32_32x32x16_bf16 v[112:127], v[240:243], v[216:219], v[112:127]
ds_read_b64_tr_b16 v[104:105], v18 offset:2048
ds_read_b64_tr_b16 v[106:107], v18 offset:3072
v_mfma_f32_32x32x16_bf16 v[128:143], v[244:247], v[216:219], v[128:143]
ds_read_b64_tr_b16 v[108:109], v19 offset:2048
ds_read_b64_tr_b16 v[110:111], v19 offset:3072
s_waitcnt vmcnt(12) lgkmcnt(8)
v_mfma_f32_32x32x16_bf16 v[112:127], v[248:251], v[220:223], v[112:127]
ds_read_b64_tr_b16 v[240:241], v18 offset:4096
ds_read_b64_tr_b16 v[242:243], v18 offset:5120
v_mfma_f32_32x32x16_bf16 v[128:143], v[252:255], v[220:223], v[128:143]
ds_read_b64_tr_b16 v[244:245], v19 offset:4096
ds_read_b64_tr_b16 v[246:247], v19 offset:5120
s_waitcnt vmcnt(11) lgkmcnt(8)
v_mfma_f32_32x32x16_bf16 v[112:127], v[96:99], v[224:227], v[112:127]
ds_read_b64_tr_b16 v[248:249], v18 offset:6144
ds_read_b64_tr_b16 v[250:251], v18 offset:7168
v_mfma_f32_32x32x16_bf16 v[128:143], v[100:103], v[224:227], v[128:143]
ds_read_b64_tr_b16 v[252:253], v19 offset:6144
ds_read_b64_tr_b16 v[254:255], v19 offset:7168
s_waitcnt vmcnt(10) lgkmcnt(8)
v_mfma_f32_32x32x16_bf16 v[112:127], v[104:107], v[228:231], v[112:127]
v_add_u32 v20, s49, v16
v_add_u32 v21, s49, v17
ds_read_b64_tr_b16 v[96:97], v20 offset:0
ds_read_b64_tr_b16 v[98:99], v20 offset:1024
v_mfma_f32_32x32x16_bf16 v[128:143], v[108:111], v[228:231], v[128:143]
ds_read_b64_tr_b16 v[100:101], v21 offset:0
ds_read_b64_tr_b16 v[102:103], v21 offset:1024
    s_lshr_b32 s20, s29, 12
    s_and_b32 s20, s20, 3
    s_cmp_eq_u32 s20, 3
    s_cbranch_scc1 L_c_ok6
buffer_load_dwordx2 v[40:41], v2, s[40:43], s32 offen sc1
s_sleep 6
buffer_load_dwordx2 v[42:43], v2, s[40:43], s32 offen sc1
s_sleep 6
L_c_poll6:
    buffer_load_dwordx2 v[44:45], v2, s[40:43], s32 offen sc1
    s_waitcnt vmcnt(2)
    v_cmp_eq_u64 vcc, s[30:31], v[40:41]
    s_add_u32 s28, s28, 1
    s_nop 4
    s_and_b32 s29, vcc_lo, 0x3fff

    s_lshr_b32 s20, s29, 12
    s_and_b32 s20, s20, 3
    s_cmp_eq_u32 s20, 3

    s_cbranch_scc1 L_c_ok6

    buffer_load_dwordx2 v[40:41], v2, s[40:43], s32 offen sc1
    s_waitcnt vmcnt(2)
    v_cmp_eq_u64 vcc, s[30:31], v[42:43]
    s_add_u32 s28, s28, 1
    s_nop 4
    s_and_b32 s29, vcc_lo, 0x3fff

    s_lshr_b32 s20, s29, 12
    s_and_b32 s20, s20, 3
    s_cmp_eq_u32 s20, 3

    s_cbranch_scc1 L_c_ok6

    buffer_load_dwordx2 v[42:43], v2, s[40:43], s32 offen sc1
    s_waitcnt vmcnt(2)
    v_cmp_eq_u64 vcc, s[30:31], v[44:45]
    s_add_u32 s28, s28, 1
    s_nop 4
    s_and_b32 s29, vcc_lo, 0x3fff

    s_lshr_b32 s20, s29, 12
    s_and_b32 s20, s20, 3
    s_cmp_eq_u32 s20, 3

    s_cbranch_scc1 L_c_ok6

    s_cmp_gt_u32 s28, 16384
    s_cbranch_scc0 L_c_poll6

L_c_ok6:
s_add_u32 s66, s66, 4096
buffer_load_dwordx4 v[80:83], v22, s[40:43], s66 offen offset:0 sc1
buffer_load_dwordx4 v[84:87], v22, s[40:43], s66 offen offset:1024 sc1
buffer_load_dwordx4 v[88:91], v22, s[40:43], s66 offen offset:2048 sc1
buffer_load_dwordx4 v[92:95], v22, s[40:43], s66 offen offset:3072 sc1
s_waitcnt vmcnt(13) lgkmcnt(8)
v_mfma_f32_32x32x16_bf16 v[112:127], v[240:243], v[232:235], v[112:127]
ds_read_b64_tr_b16 v[104:105], v20 offset:2048
ds_read_b64_tr_b16 v[106:107], v20 offset:3072
v_mfma_f32_32x32x16_bf16 v[128:143], v[244:247], v[232:235], v[128:143]
ds_read_b64_tr_b16 v[108:109], v21 offset:2048
ds_read_b64_tr_b16 v[110:111], v21 offset:3072
s_waitcnt vmcnt(12) lgkmcnt(8)
v_mfma_f32_32x32x16_bf16 v[112:127], v[248:251], v[236:239], v[112:127]
ds_read_b64_tr_b16 v[240:241], v20 offset:4096
ds_read_b64_tr_b16 v[242:243], v20 offset:5120
v_mfma_f32_32x32x16_bf16 v[128:143], v[252:255], v[236:239], v[128:143]
ds_read_b64_tr_b16 v[244:245], v21 offset:4096
ds_read_b64_tr_b16 v[246:247], v21 offset:5120
s_waitcnt vmcnt(11) lgkmcnt(8)
v_mfma_f32_32x32x16_bf16 v[112:127], v[96:99], v[48:51], v[112:127]
ds_read_b64_tr_b16 v[248:249], v20 offset:6144
ds_read_b64_tr_b16 v[250:251], v20 offset:7168
v_mfma_f32_32x32x16_bf16 v[128:143], v[100:103], v[48:51], v[128:143]
ds_read_b64_tr_b16 v[252:253], v21 offset:6144
ds_read_b64_tr_b16 v[254:255], v21 offset:7168
s_waitcnt vmcnt(10) lgkmcnt(8)
v_mfma_f32_32x32x16_bf16 v[112:127], v[104:107], v[52:55], v[112:127]
v_add_u32 v18, s50, v16
v_add_u32 v19, s50, v17
ds_read_b64_tr_b16 v[96:97], v18 offset:0
ds_read_b64_tr_b16 v[98:99], v18 offset:1024
v_mfma_f32_32x32x16_bf16 v[128:143], v[108:111], v[52:55], v[128:143]
ds_read_b64_tr_b16 v[100:101], v19 offset:0
ds_read_b64_tr_b16 v[102:103], v19 offset:1024
s_waitcnt vmcnt(9) lgkmcnt(8)
v_mfma_f32_32x32x16_bf16 v[112:127], v[240:243], v[56:59], v[112:127]
ds_read_b64_tr_b16 v[104:105], v18 offset:2048
ds_read_b64_tr_b16 v[106:107], v18 offset:3072
v_mfma_f32_32x32x16_bf16 v[128:143], v[244:247], v[56:59], v[128:143]
ds_read_b64_tr_b16 v[108:109], v19 offset:2048
ds_read_b64_tr_b16 v[110:111], v19 offset:3072
s_waitcnt vmcnt(8) lgkmcnt(8)
v_mfma_f32_32x32x16_bf16 v[112:127], v[248:251], v[60:63], v[112:127]
ds_read_b64_tr_b16 v[240:241], v18 offset:4096
ds_read_b64_tr_b16 v[242:243], v18 offset:5120
v_mfma_f32_32x32x16_bf16 v[128:143], v[252:255], v[60:63], v[128:143]
ds_read_b64_tr_b16 v[244:245], v19 offset:4096
ds_read_b64_tr_b16 v[246:247], v19 offset:5120
s_waitcnt vmcnt(7) lgkmcnt(8)
v_mfma_f32_32x32x16_bf16 v[112:127], v[96:99], v[64:67], v[112:127]
ds_read_b64_tr_b16 v[248:249], v18 offset:6144
ds_read_b64_tr_b16 v[250:251], v18 offset:7168
v_mfma_f32_32x32x16_bf16 v[128:143], v[100:103], v[64:67], v[128:143]
ds_read_b64_tr_b16 v[252:253], v19 offset:6144
ds_read_b64_tr_b16 v[254:255], v19 offset:7168
s_waitcnt vmcnt(6) lgkmcnt(8)
v_mfma_f32_32x32x16_bf16 v[112:127], v[104:107], v[68:71], v[112:127]
v_add_u32 v20, s51, v16
v_add_u32 v21, s51, v17
ds_read_b64_tr_b16 v[96:97], v20 offset:0
ds_read_b64_tr_b16 v[98:99], v20 offset:1024
v_mfma_f32_32x32x16_bf16 v[128:143], v[108:111], v[68:71], v[128:143]
ds_read_b64_tr_b16 v[100:101], v21 offset:0
ds_read_b64_tr_b16 v[102:103], v21 offset:1024
s_waitcnt vmcnt(5) lgkmcnt(8)
v_mfma_f32_32x32x16_bf16 v[112:127], v[240:243], v[72:75], v[112:127]
ds_read_b64_tr_b16 v[104:105], v20 offset:2048
ds_read_b64_tr_b16 v[106:107], v20 offset:3072
v_mfma_f32_32x32x16_bf16 v[128:143], v[244:247], v[72:75], v[128:143]
ds_read_b64_tr_b16 v[108:109], v21 offset:2048
ds_read_b64_tr_b16 v[110:111], v21 offset:3072
s_waitcnt vmcnt(4) lgkmcnt(8)
v_mfma_f32_32x32x16_bf16 v[112:127], v[248:251], v[76:79], v[112:127]
ds_read_b64_tr_b16 v[240:241], v20 offset:4096
ds_read_b64_tr_b16 v[242:243], v20 offset:5120
v_mfma_f32_32x32x16_bf16 v[128:143], v[252:255], v[76:79], v[128:143]
ds_read_b64_tr_b16 v[244:245], v21 offset:4096
ds_read_b64_tr_b16 v[246:247], v21 offset:5120
ds_read_b64_tr_b16 v[248:249], v20 offset:6144
ds_read_b64_tr_b16 v[250:251], v20 offset:7168
ds_read_b64_tr_b16 v[252:253], v21 offset:6144
ds_read_b64_tr_b16 v[254:255], v21 offset:7168
s_waitcnt vmcnt(3) lgkmcnt(12)
v_mfma_f32_32x32x16_bf16 v[128:143], v[100:103], v[80:83], v[128:143]
s_waitcnt vmcnt(2) lgkmcnt(8)
v_mfma_f32_32x32x16_bf16 v[128:143], v[108:111], v[84:87], v[128:143]
s_waitcnt vmcnt(1) lgkmcnt(4)
v_mfma_f32_32x32x16_bf16 v[128:143], v[244:247], v[88:91], v[128:143]
s_waitcnt vmcnt(0) lgkmcnt(0)
v_mfma_f32_32x32x16_bf16 v[128:143], v[252:255], v[92:95], v[128:143]
v_mfma_f32_32x32x16_bf16 v[112:127], v[96:99], v[80:83], v[112:127]
v_mfma_f32_32x32x16_bf16 v[112:127], v[104:107], v[84:87], v[112:127]
s_nop 9
ds_write_b128 v8, v[128:131] offset:0
ds_write_b128 v8, v[132:135] offset:1024
ds_write_b128 v8, v[136:139] offset:2048
ds_write_b128 v8, v[140:143] offset:3072
v_mfma_f32_32x32x16_bf16 v[112:127], v[240:243], v[88:91], v[112:127]
v_mfma_f32_32x32x16_bf16 v[112:127], v[248:251], v[92:95], v[112:127]
s_waitcnt lgkmcnt(0)
s_barrier
s_nop 7
ds_read_b128 v[48:51], v9 offset:0
ds_read_b128 v[52:55], v9 offset:1024
ds_read_b128 v[56:59], v9 offset:2048
ds_read_b128 v[60:63], v9 offset:3072
s_waitcnt lgkmcnt(3)
v_add_f32 v112, v112, v48
v_add_f32 v113, v113, v49
v_add_f32 v114, v114, v50
v_add_f32 v115, v115, v51
v_cvt_pk_bf16_f32 v64, v112, v113
v_cvt_pk_bf16_f32 v65, v114, v115
s_waitcnt lgkmcnt(2)
v_add_f32 v116, v116, v52
v_add_f32 v117, v117, v53
v_add_f32 v118, v118, v54
v_add_f32 v119, v119, v55
v_cvt_pk_bf16_f32 v66, v116, v117
v_cvt_pk_bf16_f32 v67, v118, v119
s_nop 1
v_permlane32_swap_b32 v64, v66
v_permlane32_swap_b32 v65, v67
buffer_store_dwordx4 v[64:67], v10, s[44:47], 0 offen offset:0 sc1
s_waitcnt lgkmcnt(1)
v_add_f32 v120, v120, v56
v_add_f32 v121, v121, v57
v_add_f32 v122, v122, v58
v_add_f32 v123, v123, v59
v_cvt_pk_bf16_f32 v68, v120, v121
v_cvt_pk_bf16_f32 v69, v122, v123
s_waitcnt lgkmcnt(0)
v_add_f32 v124, v124, v60
v_add_f32 v125, v125, v61
v_add_f32 v126, v126, v62
v_add_f32 v127, v127, v63
v_cvt_pk_bf16_f32 v70, v124, v125
v_cvt_pk_bf16_f32 v71, v126, v127
s_nop 1
v_permlane32_swap_b32 v68, v70
v_permlane32_swap_b32 v69, v71
buffer_store_dwordx4 v[68:71], v10, s[44:47], 0 offen offset:32 sc1
s_endpgm
L_geglu:
v_pk_mul_f32 v[24:25], v[112:113], v[112:113]
v_pk_mul_f32 v[26:27], v[114:115], v[114:115]
v_pk_mul_f32 v[28:29], v[116:117], v[116:117]
v_pk_mul_f32 v[30:31], v[118:119], v[118:119]
v_pk_fma_f32 v[24:25], v[24:25], s[68:69], v[4:5]
v_pk_fma_f32 v[26:27], v[26:27], s[68:69], v[4:5]
v_pk_fma_f32 v[28:29], v[28:29], s[68:69], v[4:5]
v_pk_fma_f32 v[30:31], v[30:31], s[68:69], v[4:5]
v_pk_mul_f32 v[24:25], v[24:25], v[112:113]
v_pk_mul_f32 v[26:27], v[26:27], v[114:115]
v_pk_mul_f32 v[28:29], v[28:29], v[116:117]
v_pk_mul_f32 v[30:31], v[30:31], v[118:119]
v_exp_f32 v24, v24
v_exp_f32 v25, v25
v_exp_f32 v26, v26
v_exp_f32 v27, v27
v_exp_f32 v28, v28
v_exp_f32 v29, v29
v_exp_f32 v30, v30
v_exp_f32 v31, v31
v_pk_mul_f32 v[112:113], v[112:113], v[120:121]
v_pk_mul_f32 v[114:115], v[114:115], v[122:123]
v_pk_mul_f32 v[116:117], v[116:117], v[124:125]
v_pk_mul_f32 v[118:119], v[118:119], v[126:127]
v_pk_add_f32 v[24:25], v[24:25], 1.0 op_sel_hi:[1,0]
v_pk_add_f32 v[26:27], v[26:27], 1.0 op_sel_hi:[1,0]
v_pk_add_f32 v[28:29], v[28:29], 1.0 op_sel_hi:[1,0]
v_pk_add_f32 v[30:31], v[30:31], 1.0 op_sel_hi:[1,0]
v_rcp_f32 v24, v24
v_rcp_f32 v25, v25
v_rcp_f32 v26, v26
v_rcp_f32 v27, v27
v_rcp_f32 v28, v28
v_rcp_f32 v29, v29
v_rcp_f32 v30, v30
v_rcp_f32 v31, v31
s_nop 0
v_pk_mul_f32 v[112:113], v[112:113], v[24:25]
v_pk_mul_f32 v[114:115], v[114:115], v[26:27]
v_pk_mul_f32 v[116:117], v[116:117], v[28:29]
v_pk_mul_f32 v[118:119], v[118:119], v[30:31]
v_cvt_pk_bf16_f32 v40, v112, v113
v_cvt_pk_bf16_f32 v41, v114, v115
v_cvt_pk_bf16_f32 v42, v116, v117
v_cvt_pk_bf16_f32 v43, v118, v119
buffer_store_dwordx4 v[40:43], v22, s[40:43], s36 offen offset:0 sc1
v_pk_mul_f32 v[32:33], v[128:129], v[128:129]
v_pk_mul_f32 v[34:35], v[130:131], v[130:131]
v_pk_mul_f32 v[36:37], v[132:133], v[132:133]
v_pk_mul_f32 v[38:39], v[134:135], v[134:135]
v_pk_fma_f32 v[32:33], v[32:33], s[68:69], v[4:5]
v_pk_fma_f32 v[34:35], v[34:35], s[68:69], v[4:5]
v_pk_fma_f32 v[36:37], v[36:37], s[68:69], v[4:5]
v_pk_fma_f32 v[38:39], v[38:39], s[68:69], v[4:5]
v_pk_mul_f32 v[32:33], v[32:33], v[128:129]
v_pk_mul_f32 v[34:35], v[34:35], v[130:131]
v_pk_mul_f32 v[36:37], v[36:37], v[132:133]
v_pk_mul_f32 v[38:39], v[38:39], v[134:135]
v_exp_f32 v32, v32
v_exp_f32 v33, v33
v_exp_f32 v34, v34
v_exp_f32 v35, v35
v_exp_f32 v36, v36
v_exp_f32 v37, v37
v_exp_f32 v38, v38
v_exp_f32 v39, v39
v_pk_mul_f32 v[128:129], v[128:129], v[136:137]
v_pk_mul_f32 v[130:131], v[130:131], v[138:139]
v_pk_mul_f32 v[132:133], v[132:133], v[140:141]
v_pk_mul_f32 v[134:135], v[134:135], v[142:143]
v_pk_add_f32 v[32:33], v[32:33], 1.0 op_sel_hi:[1,0]
v_pk_add_f32 v[34:35], v[34:35], 1.0 op_sel_hi:[1,0]
v_pk_add_f32 v[36:37], v[36:37], 1.0 op_sel_hi:[1,0]
v_pk_add_f32 v[38:39], v[38:39], 1.0 op_sel_hi:[1,0]
v_rcp_f32 v32, v32
v_rcp_f32 v33, v33
v_rcp_f32 v34, v34
v_rcp_f32 v35, v35
v_rcp_f32 v36, v36
v_rcp_f32 v37, v37
v_rcp_f32 v38, v38
v_rcp_f32 v39, v39
s_nop 0
v_pk_mul_f32 v[128:129], v[128:129], v[32:33]
v_pk_mul_f32 v[130:131], v[130:131], v[34:35]
v_pk_mul_f32 v[132:133], v[132:133], v[36:37]
v_pk_mul_f32 v[134:135], v[134:135], v[38:39]
v_cvt_pk_bf16_f32 v44, v128, v129
v_cvt_pk_bf16_f32 v45, v130, v131
v_cvt_pk_bf16_f32 v46, v132, v133
v_cvt_pk_bf16_f32 v47, v134, v135
buffer_store_dwordx4 v[44:47], v22, s[40:43], s37 offen offset:0 sc1
v_pk_mul_f32 v[24:25], v[144:145], v[144:145]
v_pk_mul_f32 v[26:27], v[146:147], v[146:147]
v_pk_mul_f32 v[28:29], v[148:149], v[148:149]
v_pk_mul_f32 v[30:31], v[150:151], v[150:151]
v_pk_fma_f32 v[24:25], v[24:25], s[68:69], v[4:5]
v_pk_fma_f32 v[26:27], v[26:27], s[68:69], v[4:5]
v_pk_fma_f32 v[28:29], v[28:29], s[68:69], v[4:5]
v_pk_fma_f32 v[30:31], v[30:31], s[68:69], v[4:5]
v_pk_mul_f32 v[24:25], v[24:25], v[144:145]
v_pk_mul_f32 v[26:27], v[26:27], v[146:147]
v_pk_mul_f32 v[28:29], v[28:29], v[148:149]
v_pk_mul_f32 v[30:31], v[30:31], v[150:151]
v_exp_f32 v24, v24
v_exp_f32 v25, v25
v_exp_f32 v26, v26
v_exp_f32 v27, v27
v_exp_f32 v28, v28
v_exp_f32 v29, v29
v_exp_f32 v30, v30
v_exp_f32 v31, v31
v_pk_mul_f32 v[144:145], v[144:145], v[152:153]
v_pk_mul_f32 v[146:147], v[146:147], v[154:155]
v_pk_mul_f32 v[148:149], v[148:149], v[156:157]
v_pk_mul_f32 v[150:151], v[150:151], v[158:159]
v_pk_add_f32 v[24:25], v[24:25], 1.0 op_sel_hi:[1,0]
v_pk_add_f32 v[26:27], v[26:27], 1.0 op_sel_hi:[1,0]
v_pk_add_f32 v[28:29], v[28:29], 1.0 op_sel_hi:[1,0]
v_pk_add_f32 v[30:31], v[30:31], 1.0 op_sel_hi:[1,0]
v_rcp_f32 v24, v24
v_rcp_f32 v25, v25
v_rcp_f32 v26, v26
v_rcp_f32 v27, v27
v_rcp_f32 v28, v28
v_rcp_f32 v29, v29
v_rcp_f32 v30, v30
v_rcp_f32 v31, v31
s_nop 0
v_pk_mul_f32 v[144:145], v[144:145], v[24:25]
v_pk_mul_f32 v[146:147], v[146:147], v[26:27]
v_pk_mul_f32 v[148:149], v[148:149], v[28:29]
v_pk_mul_f32 v[150:151], v[150:151], v[30:31]
v_cvt_pk_bf16_f32 v40, v144, v145
v_cvt_pk_bf16_f32 v41, v146, v147
v_cvt_pk_bf16_f32 v42, v148, v149
v_cvt_pk_bf16_f32 v43, v150, v151
buffer_store_dwordx4 v[40:43], v22, s[40:43], s36 offen offset:1024 sc1
v_pk_mul_f32 v[32:33], v[160:161], v[160:161]
v_pk_mul_f32 v[34:35], v[162:163], v[162:163]
v_pk_mul_f32 v[36:37], v[164:165], v[164:165]
v_pk_mul_f32 v[38:39], v[166:167], v[166:167]
v_pk_fma_f32 v[32:33], v[32:33], s[68:69], v[4:5]
v_pk_fma_f32 v[34:35], v[34:35], s[68:69], v[4:5]
v_pk_fma_f32 v[36:37], v[36:37], s[68:69], v[4:5]
v_pk_fma_f32 v[38:39], v[38:39], s[68:69], v[4:5]
v_pk_mul_f32 v[32:33], v[32:33], v[160:161]
v_pk_mul_f32 v[34:35], v[34:35], v[162:163]
v_pk_mul_f32 v[36:37], v[36:37], v[164:165]
v_pk_mul_f32 v[38:39], v[38:39], v[166:167]
v_exp_f32 v32, v32
v_exp_f32 v33, v33
v_exp_f32 v34, v34
v_exp_f32 v35, v35
v_exp_f32 v36, v36
v_exp_f32 v37, v37
v_exp_f32 v38, v38
v_exp_f32 v39, v39
v_pk_mul_f32 v[160:161], v[160:161], v[168:169]
v_pk_mul_f32 v[162:163], v[162:163], v[170:171]
v_pk_mul_f32 v[164:165], v[164:165], v[172:173]
v_pk_mul_f32 v[166:167], v[166:167], v[174:175]
v_pk_add_f32 v[32:33], v[32:33], 1.0 op_sel_hi:[1,0]
v_pk_add_f32 v[34:35], v[34:35], 1.0 op_sel_hi:[1,0]
v_pk_add_f32 v[36:37], v[36:37], 1.0 op_sel_hi:[1,0]
v_pk_add_f32 v[38:39], v[38:39], 1.0 op_sel_hi:[1,0]
v_rcp_f32 v32, v32
v_rcp_f32 v33, v33
v_rcp_f32 v34, v34
v_rcp_f32 v35, v35
v_rcp_f32 v36, v36
v_rcp_f32 v37, v37
v_rcp_f32 v38, v38
v_rcp_f32 v39, v39
s_nop 0
v_pk_mul_f32 v[160:161], v[160:161], v[32:33]
v_pk_mul_f32 v[162:163], v[162:163], v[34:35]
v_pk_mul_f32 v[164:165], v[164:165], v[36:37]
v_pk_mul_f32 v[166:167], v[166:167], v[38:39]
v_cvt_pk_bf16_f32 v44, v160, v161
v_cvt_pk_bf16_f32 v45, v162, v163
v_cvt_pk_bf16_f32 v46, v164, v165
v_cvt_pk_bf16_f32 v47, v166, v167
buffer_store_dwordx4 v[44:47], v22, s[40:43], s37 offen offset:1024 sc1
s_setpc_b64 s[8:9]
L_loader:
    s_setprio 3
    v_lshrrev_b32 v24, 3, v1
    v_mul_u32_u24 v25, 3584, v24
    v_and_b32 v26, 7, v1
    v_bfe_u32 v27, v1, 4, 1
    v_lshlrev_b32 v28, 1, v27
    v_xor_b32 v28, v26, v28
    v_lshl_add_u32 v2, v28, 4, v25
    v_xor_b32 v28, 4, v28
    v_lshl_add_u32 v6, v28, 4, v25
    s_lshl_b32 s56, s53, 8
    v_add_u32 v2, s56, v2
    v_add_u32 v6, s56, v6

v_add_u32 v3, 27648, v2
v_add_u32 v7, 27648, v6
v_add_u32 v4, 55296, v2
v_add_u32 v8, 55296, v6
v_add_u32 v5, 82944, v2
v_add_u32 v9, 82944, v6
    v_mul_u32_u24 v25, 896, v24
    v_lshlrev_b32 v28, 2, v27
    v_xor_b32 v28, v26, v28
    v_lshl_add_u32 v10, v28, 4, v25
    s_lshl_b32 s56, s55, 7
    v_add_u32 v10, s56, v10

v_add_u32 v11, 6144, v10
v_add_u32 v12, 12288, v10
v_add_u32 v13, 18432, v10
    v_lshrrev_b32 v27, 4, v1
    v_xor_b32 v28, v26, v27
    v_lshl_add_u32 v14, v28, 4, v25
    v_xor_b32 v28, 4, v28
    v_lshl_add_u32 v15, v28, 4, v25
    s_mul_i32 s56, s52, 114688
    v_add_u32 v14, s56, v14
    s_add_u32 s56, s56, 6144
    v_add_u32 v15, s56, v15
    v_add_u32 v16, 12288, v14
    v_add_u32 v17, 12288, v15

    s_cmp_eq_u32 s60, 5
    s_cselect_b32 s56, 9, s60
    s_cmp_eq_u32 s60, 6
    s_cselect_b32 s56, 5, s56
    s_lshl_b32 s72, s56, 14

    s_cmp_eq_u32 s61, 5
    s_cselect_b32 s56, 9, s61
    s_cmp_eq_u32 s61, 6
    s_cselect_b32 s56, 5, s56
    s_lshl_b32 s73, s56, 14

    s_cmp_eq_u32 s62, 5
    s_cselect_b32 s56, 9, s62
    s_cmp_eq_u32 s62, 6
    s_cselect_b32 s56, 5, s56
    s_lshl_b32 s74, s56, 14

    s_cmp_eq_u32 s63, 5
    s_cselect_b32 s56, 9, s63
    s_cmp_eq_u32 s63, 6
    s_cselect_b32 s56, 5, s56
    s_lshl_b32 s75, s56, 14

s_lshl_b32 s33, s60, 7
s_mul_i32 s44, s60, 229376
s_mul_i32 s60, s60, 229376
s_lshl_b32 s34, s61, 7
s_mul_i32 s45, s61, 229376
s_mul_i32 s61, s61, 229376
s_lshl_b32 s35, s62, 7
s_mul_i32 s46, s62, 229376
s_mul_i32 s62, s62, 229376
s_lshl_b32 s36, s63, 7
s_mul_i32 s47, s63, 229376
s_mul_i32 s63, s63, 229376
s_lshl_b32 s37, s64, 7
s_mul_i32 s48, s64, 229376
s_mul_i32 s64, s64, 229376
s_lshl_b32 s38, s65, 7
s_mul_i32 s49, s65, 229376
s_mul_i32 s65, s65, 229376
s_lshl_b32 s39, s66, 7
s_mul_i32 s50, s66, 229376
s_mul_i32 s66, s66, 229376
s_waitcnt lgkmcnt(0)
    s_mov_b32 s24, s4
    s_mov_b32 s25, s5
    s_mov_b32 s26, 1835008
    s_mov_b32 s27, 0x20000

    s_mov_b32 s28, s6
    s_mov_b32 s29, s7
    s_mov_b32 s30, 1605632
    s_mov_b32 s31, 0x20000

    s_mov_b32 s56, s8
    s_mov_b32 s57, s9
    s_mov_b32 s58, 1605632
    s_mov_b32 s59, 0x20000
    s_mov_b32 s68, s10
    s_mov_b32 s69, s11

    s_mov_b32 s20, s10
    s_mov_b32 s21, s11
    s_mov_b32 s22, 1605632
    s_mov_b32 s23, 0x20000

s_cmp_eq_u32 s18, 6
s_cbranch_scc1 L_loaderX
s_barrier
s_barrier
s_waitcnt vmcnt(47)
s_mov_b32 m0, 147456
s_add_u32 s67, s46, 0
buffer_load_dwordx4 v2, s[28:31], s67 offen offset:0 lds
buffer_load_dwordx4 v3, s[28:31], s67 offen offset:1024 lds
buffer_load_dwordx4 v4, s[28:31], s67 offen offset:2048 lds
buffer_load_dwordx4 v5, s[28:31], s67 offen offset:3072 lds
s_mov_b32 m0, 151552
s_add_u32 s67, s46, 114688
buffer_load_dwordx4 v2, s[28:31], s67 offen offset:0 lds
buffer_load_dwordx4 v3, s[28:31], s67 offen offset:1024 lds
buffer_load_dwordx4 v4, s[28:31], s67 offen offset:2048 lds
buffer_load_dwordx4 v5, s[28:31], s67 offen offset:3072 lds
s_mov_b32 m0, 155648
s_add_u32 s67, s46, 0
buffer_load_dwordx4 v6, s[56:59], s67 offen offset:0 lds
buffer_load_dwordx4 v7, s[56:59], s67 offen offset:1024 lds
buffer_load_dwordx4 v8, s[56:59], s67 offen offset:2048 lds
buffer_load_dwordx4 v9, s[56:59], s67 offen offset:3072 lds
s_mov_b32 m0, 159744
s_add_u32 s67, s46, 114688
buffer_load_dwordx4 v6, s[56:59], s67 offen offset:0 lds
buffer_load_dwordx4 v7, s[56:59], s67 offen offset:1024 lds
buffer_load_dwordx4 v8, s[56:59], s67 offen offset:2048 lds
buffer_load_dwordx4 v9, s[56:59], s67 offen offset:3072 lds
s_barrier
s_waitcnt vmcnt(47)
s_mov_b32 m0, 114688
s_add_u32 s67, s47, 0
buffer_load_dwordx4 v2, s[28:31], s67 offen offset:0 lds
buffer_load_dwordx4 v3, s[28:31], s67 offen offset:1024 lds
buffer_load_dwordx4 v4, s[28:31], s67 offen offset:2048 lds
buffer_load_dwordx4 v5, s[28:31], s67 offen offset:3072 lds
s_mov_b32 m0, 118784
s_add_u32 s67, s47, 114688
buffer_load_dwordx4 v2, s[28:31], s67 offen offset:0 lds
buffer_load_dwordx4 v3, s[28:31], s67 offen offset:1024 lds
buffer_load_dwordx4 v4, s[28:31], s67 offen offset:2048 lds
buffer_load_dwordx4 v5, s[28:31], s67 offen offset:3072 lds
s_mov_b32 m0, 122880
s_add_u32 s67, s47, 0
buffer_load_dwordx4 v6, s[56:59], s67 offen offset:0 lds
buffer_load_dwordx4 v7, s[56:59], s67 offen offset:1024 lds
buffer_load_dwordx4 v8, s[56:59], s67 offen offset:2048 lds
buffer_load_dwordx4 v9, s[56:59], s67 offen offset:3072 lds
s_mov_b32 m0, 126976
s_add_u32 s67, s47, 114688
buffer_load_dwordx4 v6, s[56:59], s67 offen offset:0 lds
buffer_load_dwordx4 v7, s[56:59], s67 offen offset:1024 lds
buffer_load_dwordx4 v8, s[56:59], s67 offen offset:2048 lds
buffer_load_dwordx4 v9, s[56:59], s67 offen offset:3072 lds
s_waitcnt vmcnt(16)
s_barrier
s_waitcnt vmcnt(47)
s_mov_b32 m0, 131072
s_add_u32 s67, s48, 0
buffer_load_dwordx4 v2, s[28:31], s67 offen offset:0 lds
buffer_load_dwordx4 v3, s[28:31], s67 offen offset:1024 lds
buffer_load_dwordx4 v4, s[28:31], s67 offen offset:2048 lds
buffer_load_dwordx4 v5, s[28:31], s67 offen offset:3072 lds
s_mov_b32 m0, 135168
s_add_u32 s67, s48, 114688
buffer_load_dwordx4 v2, s[28:31], s67 offen offset:0 lds
buffer_load_dwordx4 v3, s[28:31], s67 offen offset:1024 lds
buffer_load_dwordx4 v4, s[28:31], s67 offen offset:2048 lds
buffer_load_dwordx4 v5, s[28:31], s67 offen offset:3072 lds
s_mov_b32 m0, 139264
s_add_u32 s67, s48, 0
buffer_load_dwordx4 v6, s[56:59], s67 offen offset:0 lds
buffer_load_dwordx4 v7, s[56:59], s67 offen offset:1024 lds
buffer_load_dwordx4 v8, s[56:59], s67 offen offset:2048 lds
buffer_load_dwordx4 v9, s[56:59], s67 offen offset:3072 lds
s_mov_b32 m0, 143360
s_add_u32 s67, s48, 114688
buffer_load_dwordx4 v6, s[56:59], s67 offen offset:0 lds
buffer_load_dwordx4 v7, s[56:59], s67 offen offset:1024 lds
buffer_load_dwordx4 v8, s[56:59], s67 offen offset:2048 lds
buffer_load_dwordx4 v9, s[56:59], s67 offen offset:3072 lds
s_waitcnt vmcnt(16)
s_barrier
s_waitcnt vmcnt(47)
s_mov_b32 m0, 147456
s_add_u32 s67, s49, 0
buffer_load_dwordx4 v2, s[28:31], s67 offen offset:0 lds
buffer_load_dwordx4 v3, s[28:31], s67 offen offset:1024 lds
buffer_load_dwordx4 v4, s[28:31], s67 offen offset:2048 lds
buffer_load_dwordx4 v5, s[28:31], s67 offen offset:3072 lds
s_mov_b32 m0, 151552
s_add_u32 s67, s49, 114688
buffer_load_dwordx4 v2, s[28:31], s67 offen offset:0 lds
buffer_load_dwordx4 v3, s[28:31], s67 offen offset:1024 lds
buffer_load_dwordx4 v4, s[28:31], s67 offen offset:2048 lds
buffer_load_dwordx4 v5, s[28:31], s67 offen offset:3072 lds
s_mov_b32 m0, 155648
s_add_u32 s67, s49, 0
buffer_load_dwordx4 v6, s[56:59], s67 offen offset:0 lds
buffer_load_dwordx4 v7, s[56:59], s67 offen offset:1024 lds
buffer_load_dwordx4 v8, s[56:59], s67 offen offset:2048 lds
buffer_load_dwordx4 v9, s[56:59], s67 offen offset:3072 lds
s_mov_b32 m0, 159744
s_add_u32 s67, s49, 114688
buffer_load_dwordx4 v6, s[56:59], s67 offen offset:0 lds
buffer_load_dwordx4 v7, s[56:59], s67 offen offset:1024 lds
buffer_load_dwordx4 v8, s[56:59], s67 offen offset:2048 lds
buffer_load_dwordx4 v9, s[56:59], s67 offen offset:3072 lds
s_waitcnt vmcnt(16)
s_barrier
s_waitcnt vmcnt(47)
s_mov_b32 m0, 114688
s_add_u32 s67, s50, 0
buffer_load_dwordx4 v2, s[28:31], s67 offen offset:0 lds
buffer_load_dwordx4 v3, s[28:31], s67 offen offset:1024 lds
buffer_load_dwordx4 v4, s[28:31], s67 offen offset:2048 lds
buffer_load_dwordx4 v5, s[28:31], s67 offen offset:3072 lds
s_mov_b32 m0, 118784
s_add_u32 s67, s50, 114688
buffer_load_dwordx4 v2, s[28:31], s67 offen offset:0 lds
buffer_load_dwordx4 v3, s[28:31], s67 offen offset:1024 lds
buffer_load_dwordx4 v4, s[28:31], s67 offen offset:2048 lds
buffer_load_dwordx4 v5, s[28:31], s67 offen offset:3072 lds
s_mov_b32 m0, 122880
s_add_u32 s67, s50, 0
buffer_load_dwordx4 v6, s[56:59], s67 offen offset:0 lds
buffer_load_dwordx4 v7, s[56:59], s67 offen offset:1024 lds
buffer_load_dwordx4 v8, s[56:59], s67 offen offset:2048 lds
buffer_load_dwordx4 v9, s[56:59], s67 offen offset:3072 lds
s_mov_b32 m0, 126976
s_add_u32 s67, s50, 114688
buffer_load_dwordx4 v6, s[56:59], s67 offen offset:0 lds
buffer_load_dwordx4 v7, s[56:59], s67 offen offset:1024 lds
buffer_load_dwordx4 v8, s[56:59], s67 offen offset:2048 lds
buffer_load_dwordx4 v9, s[56:59], s67 offen offset:3072 lds
s_waitcnt vmcnt(16)
s_barrier
s_waitcnt vmcnt(47)
s_mov_b32 m0, 131072
s_add_u32 s67, s44, 128
buffer_load_dwordx4 v2, s[28:31], s67 offen offset:0 lds
buffer_load_dwordx4 v3, s[28:31], s67 offen offset:1024 lds
buffer_load_dwordx4 v4, s[28:31], s67 offen offset:2048 lds
buffer_load_dwordx4 v5, s[28:31], s67 offen offset:3072 lds
s_mov_b32 m0, 135168
s_add_u32 s67, s44, 114816
buffer_load_dwordx4 v2, s[28:31], s67 offen offset:0 lds
buffer_load_dwordx4 v3, s[28:31], s67 offen offset:1024 lds
buffer_load_dwordx4 v4, s[28:31], s67 offen offset:2048 lds
buffer_load_dwordx4 v5, s[28:31], s67 offen offset:3072 lds
s_mov_b32 m0, 139264
s_add_u32 s67, s44, 128
buffer_load_dwordx4 v6, s[56:59], s67 offen offset:0 lds
buffer_load_dwordx4 v7, s[56:59], s67 offen offset:1024 lds
buffer_load_dwordx4 v8, s[56:59], s67 offen offset:2048 lds
buffer_load_dwordx4 v9, s[56:59], s67 offen offset:3072 lds
s_mov_b32 m0, 143360
s_add_u32 s67, s44, 114816
buffer_load_dwordx4 v6, s[56:59], s67 offen offset:0 lds
buffer_load_dwordx4 v7, s[56:59], s67 offen offset:1024 lds
buffer_load_dwordx4 v8, s[56:59], s67 offen offset:2048 lds
buffer_load_dwordx4 v9, s[56:59], s67 offen offset:3072 lds
s_waitcnt vmcnt(16)
s_barrier
s_waitcnt vmcnt(47)
s_mov_b32 m0, 147456
s_add_u32 s67, s45, 128
buffer_load_dwordx4 v2, s[28:31], s67 offen offset:0 lds
buffer_load_dwordx4 v3, s[28:31], s67 offen offset:1024 lds
buffer_load_dwordx4 v4, s[28:31], s67 offen offset:2048 lds
buffer_load_dwordx4 v5, s[28:31], s67 offen offset:3072 lds
s_mov_b32 m0, 151552
s_add_u32 s67, s45, 114816
buffer_load_dwordx4 v2, s[28:31], s67 offen offset:0 lds
buffer_load_dwordx4 v3, s[28:31], s67 offen offset:1024 lds
buffer_load_dwordx4 v4, s[28:31], s67 offen offset:2048 lds
buffer_load_dwordx4 v5, s[28:31], s67 offen offset:3072 lds
s_mov_b32 m0, 155648
s_add_u32 s67, s45, 128
buffer_load_dwordx4 v6, s[56:59], s67 offen offset:0 lds
buffer_load_dwordx4 v7, s[56:59], s67 offen offset:1024 lds
buffer_load_dwordx4 v8, s[56:59], s67 offen offset:2048 lds
buffer_load_dwordx4 v9, s[56:59], s67 offen offset:3072 lds
s_mov_b32 m0, 159744
s_add_u32 s67, s45, 114816
buffer_load_dwordx4 v6, s[56:59], s67 offen offset:0 lds
buffer_load_dwordx4 v7, s[56:59], s67 offen offset:1024 lds
buffer_load_dwordx4 v8, s[56:59], s67 offen offset:2048 lds
buffer_load_dwordx4 v9, s[56:59], s67 offen offset:3072 lds
s_barrier
s_waitcnt vmcnt(47)
s_mov_b32 m0, 114688
s_add_u32 s67, s46, 128
buffer_load_dwordx4 v2, s[28:31], s67 offen offset:0 lds
buffer_load_dwordx4 v3, s[28:31], s67 offen offset:1024 lds
buffer_load_dwordx4 v4, s[28:31], s67 offen offset:2048 lds
buffer_load_dwordx4 v5, s[28:31], s67 offen offset:3072 lds
s_mov_b32 m0, 118784
s_add_u32 s67, s46, 114816
buffer_load_dwordx4 v2, s[28:31], s67 offen offset:0 lds
buffer_load_dwordx4 v3, s[28:31], s67 offen offset:1024 lds
buffer_load_dwordx4 v4, s[28:31], s67 offen offset:2048 lds
buffer_load_dwordx4 v5, s[28:31], s67 offen offset:3072 lds
s_mov_b32 m0, 122880
s_add_u32 s67, s46, 128
buffer_load_dwordx4 v6, s[56:59], s67 offen offset:0 lds
buffer_load_dwordx4 v7, s[56:59], s67 offen offset:1024 lds
buffer_load_dwordx4 v8, s[56:59], s67 offen offset:2048 lds
buffer_load_dwordx4 v9, s[56:59], s67 offen offset:3072 lds
s_mov_b32 m0, 126976
s_add_u32 s67, s46, 114816
buffer_load_dwordx4 v6, s[56:59], s67 offen offset:0 lds
buffer_load_dwordx4 v7, s[56:59], s67 offen offset:1024 lds
buffer_load_dwordx4 v8, s[56:59], s67 offen offset:2048 lds
buffer_load_dwordx4 v9, s[56:59], s67 offen offset:3072 lds
s_waitcnt vmcnt(32)
s_barrier
s_waitcnt vmcnt(16)
s_barrier
s_waitcnt vmcnt(47)
s_mov_b32 m0, 131072
s_add_u32 s67, s47, 128
buffer_load_dwordx4 v2, s[28:31], s67 offen offset:0 lds
buffer_load_dwordx4 v3, s[28:31], s67 offen offset:1024 lds
buffer_load_dwordx4 v4, s[28:31], s67 offen offset:2048 lds
buffer_load_dwordx4 v5, s[28:31], s67 offen offset:3072 lds
s_mov_b32 m0, 135168
s_add_u32 s67, s47, 114816
buffer_load_dwordx4 v2, s[28:31], s67 offen offset:0 lds
buffer_load_dwordx4 v3, s[28:31], s67 offen offset:1024 lds
buffer_load_dwordx4 v4, s[28:31], s67 offen offset:2048 lds
buffer_load_dwordx4 v5, s[28:31], s67 offen offset:3072 lds
s_mov_b32 m0, 139264
s_add_u32 s67, s47, 128
buffer_load_dwordx4 v6, s[56:59], s67 offen offset:0 lds
buffer_load_dwordx4 v7, s[56:59], s67 offen offset:1024 lds
buffer_load_dwordx4 v8, s[56:59], s67 offen offset:2048 lds
buffer_load_dwordx4 v9, s[56:59], s67 offen offset:3072 lds
s_mov_b32 m0, 143360
s_add_u32 s67, s47, 114816
buffer_load_dwordx4 v6, s[56:59], s67 offen offset:0 lds
buffer_load_dwordx4 v7, s[56:59], s67 offen offset:1024 lds
buffer_load_dwordx4 v8, s[56:59], s67 offen offset:2048 lds
buffer_load_dwordx4 v9, s[56:59], s67 offen offset:3072 lds
s_waitcnt vmcnt(16)
s_barrier
s_waitcnt vmcnt(47)
s_mov_b32 m0, 147456
s_add_u32 s67, s48, 128
buffer_load_dwordx4 v2, s[28:31], s67 offen offset:0 lds
buffer_load_dwordx4 v3, s[28:31], s67 offen offset:1024 lds
buffer_load_dwordx4 v4, s[28:31], s67 offen offset:2048 lds
buffer_load_dwordx4 v5, s[28:31], s67 offen offset:3072 lds
s_mov_b32 m0, 151552
s_add_u32 s67, s48, 114816
buffer_load_dwordx4 v2, s[28:31], s67 offen offset:0 lds
buffer_load_dwordx4 v3, s[28:31], s67 offen offset:1024 lds
buffer_load_dwordx4 v4, s[28:31], s67 offen offset:2048 lds
buffer_load_dwordx4 v5, s[28:31], s67 offen offset:3072 lds
s_mov_b32 m0, 155648
s_add_u32 s67, s48, 128
buffer_load_dwordx4 v6, s[56:59], s67 offen offset:0 lds
buffer_load_dwordx4 v7, s[56:59], s67 offen offset:1024 lds
buffer_load_dwordx4 v8, s[56:59], s67 offen offset:2048 lds
buffer_load_dwordx4 v9, s[56:59], s67 offen offset:3072 lds
s_mov_b32 m0, 159744
s_add_u32 s67, s48, 114816
buffer_load_dwordx4 v6, s[56:59], s67 offen offset:0 lds
buffer_load_dwordx4 v7, s[56:59], s67 offen offset:1024 lds
buffer_load_dwordx4 v8, s[56:59], s67 offen offset:2048 lds
buffer_load_dwordx4 v9, s[56:59], s67 offen offset:3072 lds
s_waitcnt vmcnt(16)
s_barrier
s_waitcnt vmcnt(47)
s_mov_b32 m0, 114688
s_add_u32 s67, s49, 128
buffer_load_dwordx4 v2, s[28:31], s67 offen offset:0 lds
buffer_load_dwordx4 v3, s[28:31], s67 offen offset:1024 lds
buffer_load_dwordx4 v4, s[28:31], s67 offen offset:2048 lds
buffer_load_dwordx4 v5, s[28:31], s67 offen offset:3072 lds
s_mov_b32 m0, 118784
s_add_u32 s67, s49, 114816
buffer_load_dwordx4 v2, s[28:31], s67 offen offset:0 lds
buffer_load_dwordx4 v3, s[28:31], s67 offen offset:1024 lds
buffer_load_dwordx4 v4, s[28:31], s67 offen offset:2048 lds
buffer_load_dwordx4 v5, s[28:31], s67 offen offset:3072 lds
s_mov_b32 m0, 122880
s_add_u32 s67, s49, 128
buffer_load_dwordx4 v6, s[56:59], s67 offen offset:0 lds
buffer_load_dwordx4 v7, s[56:59], s67 offen offset:1024 lds
buffer_load_dwordx4 v8, s[56:59], s67 offen offset:2048 lds
buffer_load_dwordx4 v9, s[56:59], s67 offen offset:3072 lds
s_mov_b32 m0, 126976
s_add_u32 s67, s49, 114816
buffer_load_dwordx4 v6, s[56:59], s67 offen offset:0 lds
buffer_load_dwordx4 v7, s[56:59], s67 offen offset:1024 lds
buffer_load_dwordx4 v8, s[56:59], s67 offen offset:2048 lds
buffer_load_dwordx4 v9, s[56:59], s67 offen offset:3072 lds
s_waitcnt vmcnt(16)
s_barrier
s_waitcnt vmcnt(47)
s_mov_b32 m0, 131072
s_add_u32 s67, s50, 128
buffer_load_dwordx4 v2, s[28:31], s67 offen offset:0 lds
buffer_load_dwordx4 v3, s[28:31], s67 offen offset:1024 lds
buffer_load_dwordx4 v4, s[28:31], s67 offen offset:2048 lds
buffer_load_dwordx4 v5, s[28:31], s67 offen offset:3072 lds
s_mov_b32 m0, 135168
s_add_u32 s67, s50, 114816
buffer_load_dwordx4 v2, s[28:31], s67 offen offset:0 lds
buffer_load_dwordx4 v3, s[28:31], s67 offen offset:1024 lds
buffer_load_dwordx4 v4, s[28:31], s67 offen offset:2048 lds
buffer_load_dwordx4 v5, s[28:31], s67 offen offset:3072 lds
s_mov_b32 m0, 139264
s_add_u32 s67, s50, 128
buffer_load_dwordx4 v6, s[56:59], s67 offen offset:0 lds
buffer_load_dwordx4 v7, s[56:59], s67 offen offset:1024 lds
buffer_load_dwordx4 v8, s[56:59], s67 offen offset:2048 lds
buffer_load_dwordx4 v9, s[56:59], s67 offen offset:3072 lds
s_mov_b32 m0, 143360
s_add_u32 s67, s50, 114816
buffer_load_dwordx4 v6, s[56:59], s67 offen offset:0 lds
buffer_load_dwordx4 v7, s[56:59], s67 offen offset:1024 lds
buffer_load_dwordx4 v8, s[56:59], s67 offen offset:2048 lds
buffer_load_dwordx4 v9, s[56:59], s67 offen offset:3072 lds
s_waitcnt vmcnt(16)
s_barrier
s_waitcnt vmcnt(0)
s_barrier
s_barrier
s_endpgm
L_loaderX:
s_barrier
s_barrier
s_waitcnt vmcnt(47)
s_mov_b32 m0, 32768
s_add_u32 s67, s35, 0
buffer_load_dwordx4 v14, s[24:27], s67 offen offset:0 lds
buffer_load_dwordx4 v15, s[24:27], s67 offen offset:1024 lds
buffer_load_dwordx4 v16, s[24:27], s67 offen offset:2048 lds
buffer_load_dwordx4 v17, s[24:27], s67 offen offset:3072 lds
s_mov_b32 m0, 36864
s_add_u32 s67, s35, 28672
buffer_load_dwordx4 v14, s[24:27], s67 offen offset:0 lds
buffer_load_dwordx4 v15, s[24:27], s67 offen offset:1024 lds
buffer_load_dwordx4 v16, s[24:27], s67 offen offset:2048 lds
buffer_load_dwordx4 v17, s[24:27], s67 offen offset:3072 lds
s_mov_b32 m0, 40960
s_add_u32 s67, s35, 57344
buffer_load_dwordx4 v14, s[24:27], s67 offen offset:0 lds
buffer_load_dwordx4 v15, s[24:27], s67 offen offset:1024 lds
buffer_load_dwordx4 v16, s[24:27], s67 offen offset:2048 lds
buffer_load_dwordx4 v17, s[24:27], s67 offen offset:3072 lds
s_mov_b32 m0, 45056
s_add_u32 s67, s35, 86016
buffer_load_dwordx4 v14, s[24:27], s67 offen offset:0 lds
buffer_load_dwordx4 v15, s[24:27], s67 offen offset:1024 lds
buffer_load_dwordx4 v16, s[24:27], s67 offen offset:2048 lds
buffer_load_dwordx4 v17, s[24:27], s67 offen offset:3072 lds
s_barrier
s_waitcnt vmcnt(47)
s_mov_b32 m0, 49152
s_add_u32 s67, s36, 0
buffer_load_dwordx4 v14, s[24:27], s67 offen offset:0 lds
buffer_load_dwordx4 v15, s[24:27], s67 offen offset:1024 lds
buffer_load_dwordx4 v16, s[24:27], s67 offen offset:2048 lds
buffer_load_dwordx4 v17, s[24:27], s67 offen offset:3072 lds
s_mov_b32 m0, 53248
s_add_u32 s67, s36, 28672
buffer_load_dwordx4 v14, s[24:27], s67 offen offset:0 lds
buffer_load_dwordx4 v15, s[24:27], s67 offen offset:1024 lds
buffer_load_dwordx4 v16, s[24:27], s67 offen offset:2048 lds
buffer_load_dwordx4 v17, s[24:27], s67 offen offset:3072 lds
s_mov_b32 m0, 57344
s_add_u32 s67, s36, 57344
buffer_load_dwordx4 v14, s[24:27], s67 offen offset:0 lds
buffer_load_dwordx4 v15, s[24:27], s67 offen offset:1024 lds
buffer_load_dwordx4 v16, s[24:27], s67 offen offset:2048 lds
buffer_load_dwordx4 v17, s[24:27], s67 offen offset:3072 lds
s_mov_b32 m0, 61440
s_add_u32 s67, s36, 86016
buffer_load_dwordx4 v14, s[24:27], s67 offen offset:0 lds
buffer_load_dwordx4 v15, s[24:27], s67 offen offset:1024 lds
buffer_load_dwordx4 v16, s[24:27], s67 offen offset:2048 lds
buffer_load_dwordx4 v17, s[24:27], s67 offen offset:3072 lds
s_waitcnt vmcnt(16)
s_barrier
s_waitcnt vmcnt(47)
s_mov_b32 m0, 65536
s_add_u32 s67, s37, 0
buffer_load_dwordx4 v14, s[24:27], s67 offen offset:0 lds
buffer_load_dwordx4 v15, s[24:27], s67 offen offset:1024 lds
buffer_load_dwordx4 v16, s[24:27], s67 offen offset:2048 lds
buffer_load_dwordx4 v17, s[24:27], s67 offen offset:3072 lds
s_mov_b32 m0, 69632
s_add_u32 s67, s37, 28672
buffer_load_dwordx4 v14, s[24:27], s67 offen offset:0 lds
buffer_load_dwordx4 v15, s[24:27], s67 offen offset:1024 lds
buffer_load_dwordx4 v16, s[24:27], s67 offen offset:2048 lds
buffer_load_dwordx4 v17, s[24:27], s67 offen offset:3072 lds
s_mov_b32 m0, 73728
s_add_u32 s67, s37, 57344
buffer_load_dwordx4 v14, s[24:27], s67 offen offset:0 lds
buffer_load_dwordx4 v15, s[24:27], s67 offen offset:1024 lds
buffer_load_dwordx4 v16, s[24:27], s67 offen offset:2048 lds
buffer_load_dwordx4 v17, s[24:27], s67 offen offset:3072 lds
s_mov_b32 m0, 77824
s_add_u32 s67, s37, 86016
buffer_load_dwordx4 v14, s[24:27], s67 offen offset:0 lds
buffer_load_dwordx4 v15, s[24:27], s67 offen offset:1024 lds
buffer_load_dwordx4 v16, s[24:27], s67 offen offset:2048 lds
buffer_load_dwordx4 v17, s[24:27], s67 offen offset:3072 lds
s_waitcnt vmcnt(16)
s_barrier
s_waitcnt vmcnt(47)
s_mov_b32 m0, 81920
s_add_u32 s67, s38, 0
buffer_load_dwordx4 v14, s[24:27], s67 offen offset:0 lds
buffer_load_dwordx4 v15, s[24:27], s67 offen offset:1024 lds
buffer_load_dwordx4 v16, s[24:27], s67 offen offset:2048 lds
buffer_load_dwordx4 v17, s[24:27], s67 offen offset:3072 lds
s_mov_b32 m0, 86016
s_add_u32 s67, s38, 28672
buffer_load_dwordx4 v14, s[24:27], s67 offen offset:0 lds
buffer_load_dwordx4 v15, s[24:27], s67 offen offset:1024 lds
buffer_load_dwordx4 v16, s[24:27], s67 offen offset:2048 lds
buffer_load_dwordx4 v17, s[24:27], s67 offen offset:3072 lds
s_mov_b32 m0, 90112
s_add_u32 s67, s38, 57344
buffer_load_dwordx4 v14, s[24:27], s67 offen offset:0 lds
buffer_load_dwordx4 v15, s[24:27], s67 offen offset:1024 lds
buffer_load_dwordx4 v16, s[24:27], s67 offen offset:2048 lds
buffer_load_dwordx4 v17, s[24:27], s67 offen offset:3072 lds
s_mov_b32 m0, 94208
s_add_u32 s67, s38, 86016
buffer_load_dwordx4 v14, s[24:27], s67 offen offset:0 lds
buffer_load_dwordx4 v15, s[24:27], s67 offen offset:1024 lds
buffer_load_dwordx4 v16, s[24:27], s67 offen offset:2048 lds
buffer_load_dwordx4 v17, s[24:27], s67 offen offset:3072 lds
s_waitcnt vmcnt(16)
s_barrier
s_waitcnt vmcnt(47)
s_mov_b32 m0, 98304
s_add_u32 s67, s39, 0
buffer_load_dwordx4 v14, s[24:27], s67 offen offset:0 lds
buffer_load_dwordx4 v15, s[24:27], s67 offen offset:1024 lds
buffer_load_dwordx4 v16, s[24:27], s67 offen offset:2048 lds
buffer_load_dwordx4 v17, s[24:27], s67 offen offset:3072 lds
s_mov_b32 m0, 102400
s_add_u32 s67, s39, 28672
buffer_load_dwordx4 v14, s[24:27], s67 offen offset:0 lds
buffer_load_dwordx4 v15, s[24:27], s67 offen offset:1024 lds
buffer_load_dwordx4 v16, s[24:27], s67 offen offset:2048 lds
buffer_load_dwordx4 v17, s[24:27], s67 offen offset:3072 lds
s_mov_b32 m0, 106496
s_add_u32 s67, s39, 57344
buffer_load_dwordx4 v14, s[24:27], s67 offen offset:0 lds
buffer_load_dwordx4 v15, s[24:27], s67 offen offset:1024 lds
buffer_load_dwordx4 v16, s[24:27], s67 offen offset:2048 lds
buffer_load_dwordx4 v17, s[24:27], s67 offen offset:3072 lds
s_mov_b32 m0, 110592
s_add_u32 s67, s39, 86016
buffer_load_dwordx4 v14, s[24:27], s67 offen offset:0 lds
buffer_load_dwordx4 v15, s[24:27], s67 offen offset:1024 lds
buffer_load_dwordx4 v16, s[24:27], s67 offen offset:2048 lds
buffer_load_dwordx4 v17, s[24:27], s67 offen offset:3072 lds
s_waitcnt vmcnt(16)
s_barrier
s_waitcnt vmcnt(0)
s_barrier
s_barrier
s_barrier
s_barrier
s_waitcnt vmcnt(47)
s_mov_b32 m0, 0
s_mov_b32 s67, 0
buffer_load_dwordx4 v10, s[20:23], s67 offen offset:0 lds
buffer_load_dwordx4 v11, s[20:23], s67 offen offset:1024 lds
buffer_load_dwordx4 v12, s[20:23], s67 offen offset:2048 lds
buffer_load_dwordx4 v13, s[20:23], s67 offen offset:3072 lds
s_mov_b32 m0, 4096
s_mov_b32 s67, 28672
buffer_load_dwordx4 v10, s[20:23], s67 offen offset:0 lds
buffer_load_dwordx4 v11, s[20:23], s67 offen offset:1024 lds
buffer_load_dwordx4 v12, s[20:23], s67 offen offset:2048 lds
buffer_load_dwordx4 v13, s[20:23], s67 offen offset:3072 lds
s_mov_b32 m0, 8192
s_mov_b32 s67, 114688
buffer_load_dwordx4 v10, s[20:23], s67 offen offset:0 lds
buffer_load_dwordx4 v11, s[20:23], s67 offen offset:1024 lds
buffer_load_dwordx4 v12, s[20:23], s67 offen offset:2048 lds
buffer_load_dwordx4 v13, s[20:23], s67 offen offset:3072 lds
s_mov_b32 m0, 12288
s_mov_b32 s67, 143360
buffer_load_dwordx4 v10, s[20:23], s67 offen offset:0 lds
buffer_load_dwordx4 v11, s[20:23], s67 offen offset:1024 lds
buffer_load_dwordx4 v12, s[20:23], s67 offen offset:2048 lds
buffer_load_dwordx4 v13, s[20:23], s67 offen offset:3072 lds
s_barrier
s_waitcnt vmcnt(47)
s_mov_b32 m0, 16384
s_mov_b32 s67, 229376
buffer_load_dwordx4 v10, s[20:23], s67 offen offset:0 lds
buffer_load_dwordx4 v11, s[20:23], s67 offen offset:1024 lds
buffer_load_dwordx4 v12, s[20:23], s67 offen offset:2048 lds
buffer_load_dwordx4 v13, s[20:23], s67 offen offset:3072 lds
s_mov_b32 m0, 20480
s_mov_b32 s67, 258048
buffer_load_dwordx4 v10, s[20:23], s67 offen offset:0 lds
buffer_load_dwordx4 v11, s[20:23], s67 offen offset:1024 lds
buffer_load_dwordx4 v12, s[20:23], s67 offen offset:2048 lds
buffer_load_dwordx4 v13, s[20:23], s67 offen offset:3072 lds
s_mov_b32 m0, 24576
s_mov_b32 s67, 344064
buffer_load_dwordx4 v10, s[20:23], s67 offen offset:0 lds
buffer_load_dwordx4 v11, s[20:23], s67 offen offset:1024 lds
buffer_load_dwordx4 v12, s[20:23], s67 offen offset:2048 lds
buffer_load_dwordx4 v13, s[20:23], s67 offen offset:3072 lds
s_mov_b32 m0, 28672
s_mov_b32 s67, 372736
buffer_load_dwordx4 v10, s[20:23], s67 offen offset:0 lds
buffer_load_dwordx4 v11, s[20:23], s67 offen offset:1024 lds
buffer_load_dwordx4 v12, s[20:23], s67 offen offset:2048 lds
buffer_load_dwordx4 v13, s[20:23], s67 offen offset:3072 lds
s_barrier
s_waitcnt vmcnt(47)
s_mov_b32 m0, 32768
s_mov_b32 s67, 458752
buffer_load_dwordx4 v10, s[20:23], s67 offen offset:0 lds
buffer_load_dwordx4 v11, s[20:23], s67 offen offset:1024 lds
buffer_load_dwordx4 v12, s[20:23], s67 offen offset:2048 lds
buffer_load_dwordx4 v13, s[20:23], s67 offen offset:3072 lds
s_mov_b32 m0, 36864
s_mov_b32 s67, 487424
buffer_load_dwordx4 v10, s[20:23], s67 offen offset:0 lds
buffer_load_dwordx4 v11, s[20:23], s67 offen offset:1024 lds
buffer_load_dwordx4 v12, s[20:23], s67 offen offset:2048 lds
buffer_load_dwordx4 v13, s[20:23], s67 offen offset:3072 lds
s_mov_b32 m0, 40960
s_mov_b32 s67, 573440
buffer_load_dwordx4 v10, s[20:23], s67 offen offset:0 lds
buffer_load_dwordx4 v11, s[20:23], s67 offen offset:1024 lds
buffer_load_dwordx4 v12, s[20:23], s67 offen offset:2048 lds
buffer_load_dwordx4 v13, s[20:23], s67 offen offset:3072 lds
s_mov_b32 m0, 45056
s_mov_b32 s67, 602112
buffer_load_dwordx4 v10, s[20:23], s67 offen offset:0 lds
buffer_load_dwordx4 v11, s[20:23], s67 offen offset:1024 lds
buffer_load_dwordx4 v12, s[20:23], s67 offen offset:2048 lds
buffer_load_dwordx4 v13, s[20:23], s67 offen offset:3072 lds
s_barrier
s_waitcnt vmcnt(47)
s_mov_b32 m0, 49152
s_mov_b32 s67, 688128
buffer_load_dwordx4 v10, s[20:23], s67 offen offset:0 lds
buffer_load_dwordx4 v11, s[20:23], s67 offen offset:1024 lds
buffer_load_dwordx4 v12, s[20:23], s67 offen offset:2048 lds
buffer_load_dwordx4 v13, s[20:23], s67 offen offset:3072 lds
s_mov_b32 m0, 53248
s_mov_b32 s67, 716800
buffer_load_dwordx4 v10, s[20:23], s67 offen offset:0 lds
buffer_load_dwordx4 v11, s[20:23], s67 offen offset:1024 lds
buffer_load_dwordx4 v12, s[20:23], s67 offen offset:2048 lds
buffer_load_dwordx4 v13, s[20:23], s67 offen offset:3072 lds
s_mov_b32 m0, 57344
s_mov_b32 s67, 802816
buffer_load_dwordx4 v10, s[20:23], s67 offen offset:0 lds
buffer_load_dwordx4 v11, s[20:23], s67 offen offset:1024 lds
buffer_load_dwordx4 v12, s[20:23], s67 offen offset:2048 lds
buffer_load_dwordx4 v13, s[20:23], s67 offen offset:3072 lds
s_mov_b32 m0, 61440
s_mov_b32 s67, 831488
buffer_load_dwordx4 v10, s[20:23], s67 offen offset:0 lds
buffer_load_dwordx4 v11, s[20:23], s67 offen offset:1024 lds
buffer_load_dwordx4 v12, s[20:23], s67 offen offset:2048 lds
buffer_load_dwordx4 v13, s[20:23], s67 offen offset:3072 lds
s_barrier
s_waitcnt vmcnt(47)
s_mov_b32 m0, 65536
s_mov_b32 s67, 917504
buffer_load_dwordx4 v10, s[20:23], s67 offen offset:0 lds
buffer_load_dwordx4 v11, s[20:23], s67 offen offset:1024 lds
buffer_load_dwordx4 v12, s[20:23], s67 offen offset:2048 lds
buffer_load_dwordx4 v13, s[20:23], s67 offen offset:3072 lds
s_mov_b32 m0, 69632
s_mov_b32 s67, 946176
buffer_load_dwordx4 v10, s[20:23], s67 offen offset:0 lds
buffer_load_dwordx4 v11, s[20:23], s67 offen offset:1024 lds
buffer_load_dwordx4 v12, s[20:23], s67 offen offset:2048 lds
buffer_load_dwordx4 v13, s[20:23], s67 offen offset:3072 lds
s_mov_b32 m0, 73728
s_mov_b32 s67, 1032192
buffer_load_dwordx4 v10, s[20:23], s67 offen offset:0 lds
buffer_load_dwordx4 v11, s[20:23], s67 offen offset:1024 lds
buffer_load_dwordx4 v12, s[20:23], s67 offen offset:2048 lds
buffer_load_dwordx4 v13, s[20:23], s67 offen offset:3072 lds
s_mov_b32 m0, 77824
s_mov_b32 s67, 1060864
buffer_load_dwordx4 v10, s[20:23], s67 offen offset:0 lds
buffer_load_dwordx4 v11, s[20:23], s67 offen offset:1024 lds
buffer_load_dwordx4 v12, s[20:23], s67 offen offset:2048 lds
buffer_load_dwordx4 v13, s[20:23], s67 offen offset:3072 lds
s_waitcnt vmcnt(47)
s_mov_b32 m0, 147456
s_mov_b32 s67, 1146880
buffer_load_dwordx4 v10, s[20:23], s67 offen offset:0 lds
buffer_load_dwordx4 v11, s[20:23], s67 offen offset:1024 lds
buffer_load_dwordx4 v12, s[20:23], s67 offen offset:2048 lds
buffer_load_dwordx4 v13, s[20:23], s67 offen offset:3072 lds
s_mov_b32 m0, 151552
s_mov_b32 s67, 1175552
buffer_load_dwordx4 v10, s[20:23], s67 offen offset:0 lds
buffer_load_dwordx4 v11, s[20:23], s67 offen offset:1024 lds
buffer_load_dwordx4 v12, s[20:23], s67 offen offset:2048 lds
buffer_load_dwordx4 v13, s[20:23], s67 offen offset:3072 lds
s_mov_b32 m0, 155648
s_mov_b32 s67, 1261568
buffer_load_dwordx4 v10, s[20:23], s67 offen offset:0 lds
buffer_load_dwordx4 v11, s[20:23], s67 offen offset:1024 lds
buffer_load_dwordx4 v12, s[20:23], s67 offen offset:2048 lds
buffer_load_dwordx4 v13, s[20:23], s67 offen offset:3072 lds
s_mov_b32 m0, 159744
s_mov_b32 s67, 1290240
buffer_load_dwordx4 v10, s[20:23], s67 offen offset:0 lds
buffer_load_dwordx4 v11, s[20:23], s67 offen offset:1024 lds
buffer_load_dwordx4 v12, s[20:23], s67 offen offset:2048 lds
buffer_load_dwordx4 v13, s[20:23], s67 offen offset:3072 lds
s_barrier
s_waitcnt vmcnt(47)
s_mov_b32 m0, 81920
s_mov_b32 s67, 1376256
buffer_load_dwordx4 v10, s[20:23], s67 offen offset:0 lds
buffer_load_dwordx4 v11, s[20:23], s67 offen offset:1024 lds
buffer_load_dwordx4 v12, s[20:23], s67 offen offset:2048 lds
buffer_load_dwordx4 v13, s[20:23], s67 offen offset:3072 lds
s_mov_b32 m0, 86016
s_mov_b32 s67, 1404928
buffer_load_dwordx4 v10, s[20:23], s67 offen offset:0 lds
buffer_load_dwordx4 v11, s[20:23], s67 offen offset:1024 lds
buffer_load_dwordx4 v12, s[20:23], s67 offen offset:2048 lds
buffer_load_dwordx4 v13, s[20:23], s67 offen offset:3072 lds
s_mov_b32 m0, 90112
s_mov_b32 s67, 1490944
buffer_load_dwordx4 v10, s[20:23], s67 offen offset:0 lds
buffer_load_dwordx4 v11, s[20:23], s67 offen offset:1024 lds
buffer_load_dwordx4 v12, s[20:23], s67 offen offset:2048 lds
buffer_load_dwordx4 v13, s[20:23], s67 offen offset:3072 lds
s_mov_b32 m0, 94208
s_mov_b32 s67, 1519616
buffer_load_dwordx4 v10, s[20:23], s67 offen offset:0 lds
buffer_load_dwordx4 v11, s[20:23], s67 offen offset:1024 lds
buffer_load_dwordx4 v12, s[20:23], s67 offen offset:2048 lds
buffer_load_dwordx4 v13, s[20:23], s67 offen offset:3072 lds
s_waitcnt vmcnt(47)
s_mov_b32 m0, 114688
s_add_u32 s67, s60, 57344
buffer_load_dwordx4 v10, s[20:23], s67 offen offset:0 lds
buffer_load_dwordx4 v11, s[20:23], s67 offen offset:1024 lds
buffer_load_dwordx4 v12, s[20:23], s67 offen offset:2048 lds
buffer_load_dwordx4 v13, s[20:23], s67 offen offset:3072 lds
s_mov_b32 m0, 118784
s_add_u32 s67, s60, 86016
buffer_load_dwordx4 v10, s[20:23], s67 offen offset:0 lds
buffer_load_dwordx4 v11, s[20:23], s67 offen offset:1024 lds
buffer_load_dwordx4 v12, s[20:23], s67 offen offset:2048 lds
buffer_load_dwordx4 v13, s[20:23], s67 offen offset:3072 lds
s_mov_b32 m0, 122880
s_add_u32 s67, s60, 172032
buffer_load_dwordx4 v10, s[20:23], s67 offen offset:0 lds
buffer_load_dwordx4 v11, s[20:23], s67 offen offset:1024 lds
buffer_load_dwordx4 v12, s[20:23], s67 offen offset:2048 lds
buffer_load_dwordx4 v13, s[20:23], s67 offen offset:3072 lds
s_mov_b32 m0, 126976
s_add_u32 s67, s60, 200704
buffer_load_dwordx4 v10, s[20:23], s67 offen offset:0 lds
buffer_load_dwordx4 v11, s[20:23], s67 offen offset:1024 lds
buffer_load_dwordx4 v12, s[20:23], s67 offen offset:2048 lds
buffer_load_dwordx4 v13, s[20:23], s67 offen offset:3072 lds
s_barrier
s_waitcnt vmcnt(47)
s_mov_b32 m0, 98304
s_add_u32 s67, s61, 57344
buffer_load_dwordx4 v10, s[20:23], s67 offen offset:0 lds
buffer_load_dwordx4 v11, s[20:23], s67 offen offset:1024 lds
buffer_load_dwordx4 v12, s[20:23], s67 offen offset:2048 lds
buffer_load_dwordx4 v13, s[20:23], s67 offen offset:3072 lds
s_mov_b32 m0, 102400
s_add_u32 s67, s61, 86016
buffer_load_dwordx4 v10, s[20:23], s67 offen offset:0 lds
buffer_load_dwordx4 v11, s[20:23], s67 offen offset:1024 lds
buffer_load_dwordx4 v12, s[20:23], s67 offen offset:2048 lds
buffer_load_dwordx4 v13, s[20:23], s67 offen offset:3072 lds
s_mov_b32 m0, 106496
s_add_u32 s67, s61, 172032
buffer_load_dwordx4 v10, s[20:23], s67 offen offset:0 lds
buffer_load_dwordx4 v11, s[20:23], s67 offen offset:1024 lds
buffer_load_dwordx4 v12, s[20:23], s67 offen offset:2048 lds
buffer_load_dwordx4 v13, s[20:23], s67 offen offset:3072 lds
s_mov_b32 m0, 110592
s_add_u32 s67, s61, 200704
buffer_load_dwordx4 v10, s[20:23], s67 offen offset:0 lds
buffer_load_dwordx4 v11, s[20:23], s67 offen offset:1024 lds
buffer_load_dwordx4 v12, s[20:23], s67 offen offset:2048 lds
buffer_load_dwordx4 v13, s[20:23], s67 offen offset:3072 lds
s_waitcnt vmcnt(47)
s_mov_b32 m0, 131072
s_add_u32 s67, s62, 57344
buffer_load_dwordx4 v10, s[20:23], s67 offen offset:0 lds
buffer_load_dwordx4 v11, s[20:23], s67 offen offset:1024 lds
buffer_load_dwordx4 v12, s[20:23], s67 offen offset:2048 lds
buffer_load_dwordx4 v13, s[20:23], s67 offen offset:3072 lds
s_mov_b32 m0, 135168
s_add_u32 s67, s62, 86016
buffer_load_dwordx4 v10, s[20:23], s67 offen offset:0 lds
buffer_load_dwordx4 v11, s[20:23], s67 offen offset:1024 lds
buffer_load_dwordx4 v12, s[20:23], s67 offen offset:2048 lds
buffer_load_dwordx4 v13, s[20:23], s67 offen offset:3072 lds
s_mov_b32 m0, 139264
s_add_u32 s67, s62, 172032
buffer_load_dwordx4 v10, s[20:23], s67 offen offset:0 lds
buffer_load_dwordx4 v11, s[20:23], s67 offen offset:1024 lds
buffer_load_dwordx4 v12, s[20:23], s67 offen offset:2048 lds
buffer_load_dwordx4 v13, s[20:23], s67 offen offset:3072 lds
s_mov_b32 m0, 143360
s_add_u32 s67, s62, 200704
buffer_load_dwordx4 v10, s[20:23], s67 offen offset:0 lds
buffer_load_dwordx4 v11, s[20:23], s67 offen offset:1024 lds
buffer_load_dwordx4 v12, s[20:23], s67 offen offset:2048 lds
buffer_load_dwordx4 v13, s[20:23], s67 offen offset:3072 lds
s_waitcnt vmcnt(0)
s_barrier
s_barrier
s_waitcnt vmcnt(47)
s_add_u32 m0, s72, 0
s_add_u32 s67, s63, 57344
buffer_load_dwordx4 v10, s[20:23], s67 offen offset:0 lds
buffer_load_dwordx4 v11, s[20:23], s67 offen offset:1024 lds
buffer_load_dwordx4 v12, s[20:23], s67 offen offset:2048 lds
buffer_load_dwordx4 v13, s[20:23], s67 offen offset:3072 lds
s_add_u32 m0, s72, 4096
s_add_u32 s67, s63, 86016
buffer_load_dwordx4 v10, s[20:23], s67 offen offset:0 lds
buffer_load_dwordx4 v11, s[20:23], s67 offen offset:1024 lds
buffer_load_dwordx4 v12, s[20:23], s67 offen offset:2048 lds
buffer_load_dwordx4 v13, s[20:23], s67 offen offset:3072 lds
s_add_u32 m0, s72, 8192
s_add_u32 s67, s63, 172032
buffer_load_dwordx4 v10, s[20:23], s67 offen offset:0 lds
buffer_load_dwordx4 v11, s[20:23], s67 offen offset:1024 lds
buffer_load_dwordx4 v12, s[20:23], s67 offen offset:2048 lds
buffer_load_dwordx4 v13, s[20:23], s67 offen offset:3072 lds
s_add_u32 m0, s72, 12288
s_add_u32 s67, s63, 200704
buffer_load_dwordx4 v10, s[20:23], s67 offen offset:0 lds
buffer_load_dwordx4 v11, s[20:23], s67 offen offset:1024 lds
buffer_load_dwordx4 v12, s[20:23], s67 offen offset:2048 lds
buffer_load_dwordx4 v13, s[20:23], s67 offen offset:3072 lds
s_waitcnt vmcnt(47)
s_add_u32 m0, s73, 0
s_add_u32 s67, s64, 57344
buffer_load_dwordx4 v10, s[20:23], s67 offen offset:0 lds
buffer_load_dwordx4 v11, s[20:23], s67 offen offset:1024 lds
buffer_load_dwordx4 v12, s[20:23], s67 offen offset:2048 lds
buffer_load_dwordx4 v13, s[20:23], s67 offen offset:3072 lds
s_add_u32 m0, s73, 4096
s_add_u32 s67, s64, 86016
buffer_load_dwordx4 v10, s[20:23], s67 offen offset:0 lds
buffer_load_dwordx4 v11, s[20:23], s67 offen offset:1024 lds
buffer_load_dwordx4 v12, s[20:23], s67 offen offset:2048 lds
buffer_load_dwordx4 v13, s[20:23], s67 offen offset:3072 lds
s_add_u32 m0, s73, 8192
s_add_u32 s67, s64, 172032
buffer_load_dwordx4 v10, s[20:23], s67 offen offset:0 lds
buffer_load_dwordx4 v11, s[20:23], s67 offen offset:1024 lds
buffer_load_dwordx4 v12, s[20:23], s67 offen offset:2048 lds
buffer_load_dwordx4 v13, s[20:23], s67 offen offset:3072 lds
s_add_u32 m0, s73, 12288
s_add_u32 s67, s64, 200704
buffer_load_dwordx4 v10, s[20:23], s67 offen offset:0 lds
buffer_load_dwordx4 v11, s[20:23], s67 offen offset:1024 lds
buffer_load_dwordx4 v12, s[20:23], s67 offen offset:2048 lds
buffer_load_dwordx4 v13, s[20:23], s67 offen offset:3072 lds
s_waitcnt vmcnt(47)
s_add_u32 m0, s74, 0
s_add_u32 s67, s65, 57344
buffer_load_dwordx4 v10, s[20:23], s67 offen offset:0 lds
buffer_load_dwordx4 v11, s[20:23], s67 offen offset:1024 lds
buffer_load_dwordx4 v12, s[20:23], s67 offen offset:2048 lds
buffer_load_dwordx4 v13, s[20:23], s67 offen offset:3072 lds
s_add_u32 m0, s74, 4096
s_add_u32 s67, s65, 86016
buffer_load_dwordx4 v10, s[20:23], s67 offen offset:0 lds
buffer_load_dwordx4 v11, s[20:23], s67 offen offset:1024 lds
buffer_load_dwordx4 v12, s[20:23], s67 offen offset:2048 lds
buffer_load_dwordx4 v13, s[20:23], s67 offen offset:3072 lds
s_add_u32 m0, s74, 8192
s_add_u32 s67, s65, 172032
buffer_load_dwordx4 v10, s[20:23], s67 offen offset:0 lds
buffer_load_dwordx4 v11, s[20:23], s67 offen offset:1024 lds
buffer_load_dwordx4 v12, s[20:23], s67 offen offset:2048 lds
buffer_load_dwordx4 v13, s[20:23], s67 offen offset:3072 lds
s_add_u32 m0, s74, 12288
s_add_u32 s67, s65, 200704
buffer_load_dwordx4 v10, s[20:23], s67 offen offset:0 lds
buffer_load_dwordx4 v11, s[20:23], s67 offen offset:1024 lds
buffer_load_dwordx4 v12, s[20:23], s67 offen offset:2048 lds
buffer_load_dwordx4 v13, s[20:23], s67 offen offset:3072 lds
s_waitcnt vmcnt(47)
s_add_u32 m0, s75, 0
s_add_u32 s67, s66, 57344
buffer_load_dwordx4 v10, s[20:23], s67 offen offset:0 lds
buffer_load_dwordx4 v11, s[20:23], s67 offen offset:1024 lds
buffer_load_dwordx4 v12, s[20:23], s67 offen offset:2048 lds
buffer_load_dwordx4 v13, s[20:23], s67 offen offset:3072 lds
s_add_u32 m0, s75, 4096
s_add_u32 s67, s66, 86016
buffer_load_dwordx4 v10, s[20:23], s67 offen offset:0 lds
buffer_load_dwordx4 v11, s[20:23], s67 offen offset:1024 lds
buffer_load_dwordx4 v12, s[20:23], s67 offen offset:2048 lds
buffer_load_dwordx4 v13, s[20:23], s67 offen offset:3072 lds
s_add_u32 m0, s75, 8192
s_add_u32 s67, s66, 172032
buffer_load_dwordx4 v10, s[20:23], s67 offen offset:0 lds
buffer_load_dwordx4 v11, s[20:23], s67 offen offset:1024 lds
buffer_load_dwordx4 v12, s[20:23], s67 offen offset:2048 lds
buffer_load_dwordx4 v13, s[20:23], s67 offen offset:3072 lds
s_add_u32 m0, s75, 12288
s_add_u32 s67, s66, 200704
buffer_load_dwordx4 v10, s[20:23], s67 offen offset:0 lds
buffer_load_dwordx4 v11, s[20:23], s67 offen offset:1024 lds
buffer_load_dwordx4 v12, s[20:23], s67 offen offset:2048 lds
buffer_load_dwordx4 v13, s[20:23], s67 offen offset:3072 lds
s_waitcnt vmcnt(0)
s_barrier
s_endpgm
L_poller:
    s_setprio 3
    s_mul_i32 s56, s21, 112
    v_lshrrev_b32 v4, 3, v1
    v_add_u32 v4, s56, v4
    v_mul_u32_u24 v4, 3584, v4
    v_and_b32 v5, 7, v1
    v_lshl_add_u32 v4, v5, 4, v4
    s_lshl_b32 s56, s53, 8
    s_add_u32 s56, s56, 128
    v_add_u32 v4, s56, v4
    v_lshrrev_b32 v16, 3, v1
    s_and_b32 s56, s21, 1
    s_lshl_b32 s56, s56, 5
    v_add_u32 v16, s56, v16
    v_mul_u32_u24 v16, 3584, v16
    v_lshl_add_u32 v16, v5, 4, v16
    s_lshl_b32 s56, s53, 8
    v_add_u32 v16, s56, v16
    s_add_u32 s60, s22, 4
    s_cmp_ge_u32 s60, 7
    s_cselect_b32 s56, 7, 0
    s_sub_u32 s60, s60, s56
    s_add_u32 s61, s60, 1
    s_cmp_ge_u32 s61, 7
    s_cselect_b32 s56, 7, 0
    s_sub_u32 s61, s61, s56
    s_add_u32 s62, s61, 1
    s_cmp_ge_u32 s62, 7
    s_cselect_b32 s56, 7, 0
    s_sub_u32 s62, s62, s56
    s_mul_i32 s60, s60, 229376
    s_mul_i32 s61, s61, 229376
    s_mul_i32 s62, s62, 229376
    v_mov_b32 v2, 0
    v_lshlrev_b32 v13, 20, v1
    s_waitcnt lgkmcnt(0)

    s_mov_b32 s28, s6
    s_mov_b32 s29, s7
    s_mov_b32 s30, 1605632
    s_mov_b32 s31, 0x20000

    s_mov_b32 s32, s8
    s_mov_b32 s33, s9
    s_mov_b32 s34, 1605632
    s_mov_b32 s35, 0x20000

    s_mov_b32 s40, s16
    s_mov_b32 s41, s17
    s_mov_b32 s42, 9437184
    s_mov_b32 s43, 0x20000

    s_mov_b32 s44, s12
    s_mov_b32 s45, s13
    s_mov_b32 s46, 1835008
    s_mov_b32 s47, 0x20000

    s_mov_b32 s48, s14
    s_mov_b32 s49, s15
    s_mov_b32 s50, 256
    s_mov_b32 s51, 0x20000

    s_lshr_b32 s56, s21, 1
    s_cmp_eq_u32 s56, 0
    s_cselect_b32 s64, s6, s8
    s_cselect_b32 s65, s7, s9
    s_mov_b32 s66, 1605632
    s_mov_b32 s67, 0x20000

    s_cmp_lg_u32 s2, 0
    s_cbranch_scc1 L_p_nonce
    s_memrealtime s[70:71]
    s_waitcnt lgkmcnt(0)
    v_mov_b32 v6, s70
    v_mov_b32 v7, s71
    s_mov_b64 exec, 1
    buffer_store_dwordx2 v[6:7], v2, s[48:51], 0 offen sc1
    s_mov_b64 exec, -1
L_p_nonce:

s_barrier
    s_mov_b64 exec, 0x1ff
    buffer_load_dword v14, v13, s[40:43], 0 offen
    s_mov_b64 exec, 3
    buffer_load_dword v15, v13, s[44:47], 0 offen
    s_mov_b64 exec, -1
    s_lshl_b32 s72, s52, 4
    s_add_u32 s72, s72, s53
    s_lshl_b32 s72, s72, 7
    s_add_u32 s72, s72, 8388608
    s_add_u32 s73, s72, 32768
    s_lshr_b32 s74, s54, 1
    s_lshl_b32 s74, s74, 11
    s_add_u32 s74, s74, 8388608
    s_add_u32 s75, s74, 32768
    v_min_u32 v8, 13, v1
    v_lshlrev_b32 v8, 7, v8

s_barrier
s_barrier
s_barrier
s_barrier
s_barrier
s_barrier
s_barrier
buffer_load_dwordx2 v[6:7], v2, s[48:51], 0 offen sc1
s_barrier
s_barrier
s_barrier
    s_mov_b32 s76, 0
L_p_chknonce:
    s_waitcnt vmcnt(0)
    v_readfirstlane_b32 s70, v6
    v_readfirstlane_b32 s71, v7
    s_add_u32 s76, s76, 1
    s_nop 3
    s_or_b32 s56, s70, s71
    s_cmp_lg_u32 s56, 0
    s_cbranch_scc1 L_p_havenonce
    s_cmp_gt_u32 s76, 16384
    s_cbranch_scc1 L_p_havenonce
    buffer_load_dwordx2 v[6:7], v2, s[48:51], 0 offen sc1
    s_branch L_p_chknonce
L_p_havenonce:
    s_barrier
    s_mov_b64 exec, 1
    buffer_store_dwordx2 v[6:7], v2, s[40:43], s72 offen sc1
    s_mov_b64 exec, -1
    s_barrier
    s_barrier
    buffer_load_dwordx2 v[10:11], v8, s[40:43], s74 offen sc1
    s_barrier
    s_mov_b32 s76, 0
L_p_pollA:
    buffer_load_dwordx2 v[12:13], v8, s[40:43], s74 offen sc1
    s_waitcnt vmcnt(1)
    v_cmp_ne_u64 vcc, s[70:71], v[10:11]
    s_add_u32 s76, s76, 1
    s_nop 4
    s_cbranch_vccz L_p_gotA
    buffer_load_dwordx2 v[10:11], v8, s[40:43], s74 offen sc1
    s_waitcnt vmcnt(1)
    v_cmp_ne_u64 vcc, s[70:71], v[12:13]
    s_nop 4
    s_cbranch_vccz L_p_gotA
    s_cmp_gt_u32 s76, 16384
    s_cbranch_scc0 L_p_pollA
L_p_gotA:
    s_barrier
    s_barrier
    s_barrier
    s_endpgm
L_helper:
    s_sub_u32 s56, s2, 224
    s_lshr_b32 s56, s56, 3
    s_mul_i32 s56, s56, 7
    s_add_u32 s56, s56, s18
    v_lshlrev_b32 v2, 4, v1
    s_getpc_b64 s[40:41]
L_pc_here:
    s_add_u32 s40, s40, KSTART-L_pc_here
    s_addc_u32 s41, s41, -1
    s_lshl_b32 s57, s56, 10
    v_add_u32 v3, s57, v2
    v_min_u32 v3, KEND-KSTART-16, v3
    global_load_dwordx4 v[8:11], v3, s[40:41]
    v_add_u32 v3, 24576, v3
    v_min_u32 v3, KEND-KSTART-16, v3
    global_load_dwordx4 v[12:15], v3, s[40:41]
    s_waitcnt lgkmcnt(0)
    s_mov_b32 s36, s10
    s_mov_b32 s37, s11
    s_mov_b32 s38, 1605632
    s_mov_b32 s39, 0x20000
    s_mul_i32 s62, s19, 7
    s_lshr_b32 s62, s62, 2
L_h_loop:
    s_cmp_ge_u32 s56, 784
    s_cselect_b32 s60, 784, 0
    s_cselect_b32 s61, 57344, 0
    s_sub_u32 s60, s56, s60
    s_mul_i32 s58, s60, 1171
    s_lshr_b32 s58, s58, 16
    s_mul_i32 s59, s58, 56
    s_sub_u32 s59, s60, s59
    s_lshl_b32 s59, s59, 10
    s_add_u32 s58, s58, s62
    s_cmp_ge_u32 s58, 14
    s_cselect_b32 s63, 14, 0
    s_sub_u32 s58, s58, s63
    s_mul_i32 s58, s58, 114688
    s_add_u32 s58, s58, s59
    s_add_u32 s58, s58, s61
    buffer_load_dwordx4 v[4:7], v2, s[36:39], s58 offen
    s_waitcnt vmcnt(40)
    s_add_u32 s56, s56, 28
    s_cmp_lt_u32 s56, 1568
    s_cbranch_scc1 L_h_loop
L_end:
    s_endpgm
KEND:

.section .rodata,"a"
.p2align 6
.amdhsa_kernel standalone__geglu_ffn__prompt_kernel
  .amdhsa_next_free_vgpr 256
  .amdhsa_next_free_sgpr 102
  .amdhsa_accum_offset 256
  .amdhsa_group_segment_fixed_size 0
  .amdhsa_kernarg_size 56
  .amdhsa_user_sgpr_count 2
  .amdhsa_user_sgpr_kernarg_segment_ptr 1
  .amdhsa_system_sgpr_workgroup_id_x 1
.end_amdhsa_kernel
```
